```python
import torch

def _softmax(x, axis=-1):
    return torch.softmax(x, dim=axis)
def _gelu(x):
    return torch.nn.functional.gelu(x, approximate="tanh")
def _silu(x):
    return torch.nn.functional.silu(x)
def _sigmoid(x):
    return torch.sigmoid(x)
def _layernorm(x, axis=-1, eps=1e-5):
    m = x.mean(dim=axis, keepdim=True)
    v = x.var(dim=axis, keepdim=True, unbiased=False)
    return (x - m) / torch.sqrt(v + eps)
def _scatter_add(tgt, idx, src, axis=0):
    return tgt.clone().index_add_(axis, idx, src)
def _segment_sum(src, seg, n):
    out = torch.zeros((n,) + src.shape[1:], dtype=src.dtype)
    return out.index_add_(0, seg, src)
def _pad(x, pw):
    flat = tuple(v for pair in reversed(pw) for v in pair)
    return torch.nn.functional.pad(x, flat)

kernel_name = 'sequential_preLN__sliding_block_cached__dense_activation_squared_relu__decode'

def setup_inputs():

    _w = (lambda a: (lambda t: t.to(torch.bfloat16) if t.is_floating_point() else t)(torch.as_tensor(a)))
    def _A_setup():
        B, Sq, D = 1, 1, 640
        Hq, Hkv, Sk, Dh = 32, 32, 32768, 192
        assert Hq % Hkv == 0, (Hq, Hkv)
        return {
            "x": _w((lambda *s: torch.randn(*s, dtype=torch.bfloat16) * 0.05)(B, Sq, D)),
            "k_cache": _w((lambda *s: torch.randn(*s, dtype=torch.bfloat16) * 3.2)(B, Hkv, Sk, Dh)),
            "v_cache": _w((lambda *s: torch.randn(*s, dtype=torch.bfloat16) * 0.4)(B, Hkv, Sk, Dh)),
            "wq": _w((lambda *s: torch.randn(*s, dtype=torch.bfloat16) * 3.2)(D, Hq * Dh) * (D ** -0.5)),
            "wo": _w((lambda *s: torch.randn(*s, dtype=torch.bfloat16) * 0.4)(Hq * Dh, D) * ((Hq * Dh) ** -0.5)),
        }
    _A_in = _A_setup()

    def _B_setup():
        B, S, D, F = 1, 1, 640, 1536
        return {
            "x": _w((lambda *s: torch.randn(*s, dtype=torch.bfloat16) * 0.05)(B, S, D)),
            "w1": _w((lambda *s: torch.randn(*s, dtype=torch.bfloat16) * 0.05)(D, F)),
            "b1": _w((lambda *s: torch.randn(*s, dtype=torch.bfloat16) * 0.8)(F)),
            "w2": _w((lambda *s: torch.randn(*s, dtype=torch.bfloat16) * 0.05)(F, D)),
            "b2": _w((lambda *s: torch.randn(*s, dtype=torch.bfloat16) * 3.2)(D)),
        }
    _B_in = _B_setup()

    return {
        "A_x": _A_in["x"],
        "A_k_cache": _A_in["k_cache"],
        "A_v_cache": _A_in["v_cache"],
        "A_wq": _A_in["wq"],
        "A_wo": _A_in["wo"],
        "B_x": _B_in["x"],
        "B_w1": _B_in["w1"],
        "B_b1": _B_in["b1"],
        "B_w2": _B_in["w2"],
        "B_b2": _B_in["b2"],
    }

def reference(A_x, A_k_cache, A_v_cache, A_wq, A_wo, B_x, B_w1, B_b1, B_w2, B_b2):
    def _A_ref(x, k_cache, v_cache, wq, wo):
        B, Sq, D = x.shape
        Hq, Dh = 32, 192
        Hkv, Sk = k_cache.shape[1], k_cache.shape[2]
        W = min(4096, max(256, Sk // 4))
        rep = Hq // Hkv
        q = (lambda x, *d: x.permute(*d))((x @ wq).reshape(B, Sq, Hq, Dh), 0, 2, 1, 3)
        k = (lambda x, n, axis: torch.repeat_interleave(x, n, dim=axis))(k_cache[:, :, Sk - W:, :], rep, axis=1)
        v = (lambda x, n, axis: torch.repeat_interleave(x, n, dim=axis))(v_cache[:, :, Sk - W:, :], rep, axis=1)
        scores = torch.einsum("bhqd,bhkd->bhqk", q, k) * (Dh ** -0.5)
        p = _softmax(scores, axis=-1)
        o = torch.einsum("bhqk,bhkd->bhqd", p, v)
        return (lambda x, *d: x.permute(*d))(o, 0, 2, 1, 3).reshape(B, Sq, Hq * Dh) @ wo

    def _B_ref(x, w1, b1, w2, b2):
        h = torch.einsum("bsd,df->bsf", x, w1) + b1
        zero = torch.zeros_like(h)
        r = torch.where(h > zero, h, zero)
        h = r * r
        out = torch.einsum("bsf,fd->bsd", h, w2) + b2
        return out

    x = A_x
    h = x + _A_ref(_layernorm(x, axis=-1), A_k_cache, A_v_cache, A_wq, A_wo)
    h2 = h + _B_ref(_layernorm(h, axis=-1), B_w1, B_b1, B_w2, B_b2)
    return h2
```

```asm
; @launch grid=(256,1,1) block=(512,1,1) lds=79872
.amdgcn_target "amdgcn-amd-amdhsa--gfx950"
.text
.globl sequential_preLN__sliding_block_cached__dense_activation_squared_relu__decode_kernel
.p2align 8
.type sequential_preLN__sliding_block_cached__dense_activation_squared_relu__decode_kernel,@function
sequential_preLN__sliding_block_cached__dense_activation_squared_relu__decode_kernel:
    s_load_dwordx2 s[32:33], s[0:1], 24
    s_load_dwordx2 s[20:21], s[0:1], 0
    s_cmp_ge_u32 s2, 256
    s_cbranch_scc1 L_exit
    v_lshrrev_b32 v44, 6, v0
    v_and_b32 v0, 63, v0
    v_readfirstlane_b32 s3, v44
    s_lshr_b32 s6, s2, 3
    s_and_b32 s7, s2, 7
    s_lshr_b32 s4, s6, 4
    s_and_b32 s5, s6, 15
    s_lshl1_add_u32 s4, s7, s4
    s_mov_b32 s34, 7864320
    s_mov_b32 s35, 0x20000
    s_movk_i32 s22, 1280
    s_mov_b32 s23, 0x20000
    v_lshrrev_b32 v44, 3, v0
    v_and_b32 v45, 7, v0
    v_lshlrev_b32 v46, 4, v45
    s_movk_i32 s16, 12288
    v_mad_u32_u24 v3, v44, s16, v46
    s_lshl3_add_u32 s17, s7, s3
    s_mul_i32 s17, s17, 10
    v_and_b32 v47, 1, v44
    v_lshrrev_b32 v48, 4, v0
    v_mad_u32_u24 v49, v47, s16, v46
    v_lshl_add_u32 v49, v48, 7, v49
    v_add_u32 v54, 16, v0
    v_lshrrev_b32 v54, 6, v54
    v_lshl_add_u32 v54, v54, 30, v49
    v_add_lshl_u32 v50, v44, s17, 1
    v_add_lshl_u32 v51, v47, s17, 1
    v_lshlrev_b32 v52, 4, v0
    v_lshlrev_b32 v53, 2, v0
    s_mul_i32 s17, s17, 12288
    s_mul_i32 s14, s6, 384
    s_add_u32 s17, s17, s14
    s_add_u32 s18, s17, 98304
    s_lshl3_add_u32 s59, s2, s3
    s_cmp_eq_u32 s59, 9
    s_cbranch_scc1 L_lead
L_leadret:
    s_waitcnt lgkmcnt(0)
    buffer_load_dwordx4 v[160:163], v3, s[32:35], s17 offen offset:0
    buffer_load_dwordx4 v[164:167], v3, s[32:35], s17 offen offset:128
    buffer_load_dwordx4 v[168:171], v3, s[32:35], s17 offen offset:256
    buffer_load_dwordx4 v[172:175], v54, s[32:35], s18 offen
    buffer_load_dwordx4 v[8:11], v52, s[20:23], 0 offen
    buffer_load_dword v12, v53, s[20:23], 0 offen offset:1024
    buffer_load_ushort v13, v50, s[20:23], 0 offen
    buffer_load_ushort v14, v51, s[20:23], 0 offen offset:16
    s_load_dwordx2 s[36:37], s[0:1], 96
    s_load_dwordx2 s[40:41], s[0:1], 88
    s_load_dwordx2 s[24:25], s[0:1], 8
    s_load_dwordx2 s[28:29], s[0:1], 16
    s_load_dwordx2 s[52:53], s[0:1], 80
    s_load_dwordx2 s[60:61], s[0:1], 64
    s_lshl4_add_u32 s13, s4, s5
    s_mul_i32 s13, s13, 384
    s_add_u32 s13, s13, 819200
    s_mul_i32 s57, s2, 768
    s_add_u32 s57, s57, 622592
    s_mov_b32 s38, 1015808
    s_mov_b32 s39, 0x20000
    s_mov_b32 s47, 0x20000
    s_mov_b32 s62, 1966080
    s_mov_b32 s63, 0x20000
    v_and_b32 v49, 1, v0
    v_mov_b32 v16, -1
    v_mov_b32 v17, -1
    v_mov_b32 v18, -1
    v_mov_b32 v19, -1
    s_and_b32 s19, s3, 3
    s_cmp_ge_u32 s6, 20
    s_waitcnt lgkmcnt(0)
    s_cbranch_scc1 L_setffn
    s_load_dwordx2 s[44:45], s[0:1], 32
    s_load_dwordx2 s[48:49], s[0:1], 72
    s_mov_b32 s12, 0
    s_cmp_ge_u32 s6, 10
    s_cselect_b32 s69, 1, 0
    s_cselect_b32 s14, 10, 0
    s_lshl1_add_u32 s69, s7, s69
    s_sub_u32 s68, s6, s14
    s_mov_b32 s46, 7864320
    s_movk_i32 s50, 1280
    s_lshr_b32 s14, s19, 1
    s_mul_i32 s14, s14, 32
    s_and_b32 s16, s19, 1
    s_mul_i32 s16, s16, 1
    s_add_u32 s16, s16, s14
    s_lshl1_add_u32 s16, s69, s16
    s_mul_i32 s16, s16, 122880
    s_lshl_b32 s14, s68, 7
    s_add_u32 s16, s16, s14
    v_mul_u32_u24 v47, 1280, v44
    v_and_b32 v48, 2, v44
    v_xor_b32 v48, v48, v45
    v_lshl_add_u32 v47, v48, 4, v47
    v_add_u32 v59, s16, v47
    v_xor_b32 v62, 64, v59
    s_lshr_b32 s65, s3, 2
    s_mul_i32 s19, s19, 12288
    s_mul_i32 s64, s65, 10240
    s_lshl_b32 s14, s65, 6
    v_xor_b32 v3, s14, v59
    s_lshl_b32 s65, s65, 10
    s_add_u32 s65, s65, s19
    s_branch L_setdone
L_lead:
    s_load_dwordx2 s[36:37], s[0:1], 96
    s_load_dwordx2 s[40:41], s[0:1], 88
    s_mov_b32 s38, 1015808
    s_mov_b32 s39, 0x20000
    s_movk_i32 s42, 256
    s_mov_b32 s43, 0x20000
    v_mov_b32 v16, -1
    v_mov_b32 v17, -1
    v_mov_b32 v18, -1
    v_mov_b32 v19, -1
    s_mov_b32 s14, 0
    s_waitcnt lgkmcnt(0)
    buffer_store_dwordx4 v[16:19], v52, s[36:39], s14 offen offset:0 sc1
    buffer_store_dwordx4 v[16:19], v52, s[36:39], s14 offen offset:1024 sc1
    buffer_store_dwordx4 v[16:19], v52, s[36:39], s14 offen offset:2048 sc1
    buffer_store_dwordx4 v[16:19], v52, s[36:39], s14 offen offset:3072 sc1
    s_mov_b32 s14, 4096
    buffer_store_dwordx4 v[16:19], v52, s[36:39], s14 offen offset:0 sc1
    buffer_store_dwordx4 v[16:19], v52, s[36:39], s14 offen offset:1024 sc1
    buffer_store_dwordx4 v[16:19], v52, s[36:39], s14 offen offset:2048 sc1
    buffer_store_dwordx4 v[16:19], v52, s[36:39], s14 offen offset:3072 sc1
    s_mov_b32 s14, 8192
    buffer_store_dwordx4 v[16:19], v52, s[36:39], s14 offen offset:0 sc1
    s_mov_b32 s14, 16384
    buffer_store_dwordx4 v[16:19], v52, s[36:39], s14 offen sc1
    s_mov_b32 s14, 24576
    buffer_store_dwordx4 v[16:19], v52, s[36:39], s14 offen sc1
    s_mov_b64 exec, 1
    buffer_load_dword v15, v0, s[40:43], 0 offen offset:128 sc1
    s_mov_b64 exec, -1
    s_branch L_leadret
L_setffn:
    s_load_dwordx2 s[44:45], s[0:1], 48
    s_load_dwordx2 s[48:49], s[0:1], 56
    s_mov_b32 s12, 1
    s_mov_b32 s69, 0
    s_mov_b32 s46, 1966080
    s_movk_i32 s50, 3072
    s_mul_i32 s68, s7, 12
    s_add_u32 s68, s68, s6
    s_sub_u32 s68, s68, 20
    s_mul_i32 s16, s3, 245760
    s_lshl_b32 s14, s68, 5
    s_add_u32 s16, s16, s14
    v_lshrrev_b32 v47, 1, v0
    v_mul_u32_u24 v47, 3072, v47
    v_lshl_add_u32 v47, v49, 4, v47
    v_add_u32 v59, s16, v47
    s_mul_i32 s19, s19, 5120
    v_mov_b32 v62, 0
    s_mov_b32 s64, 0
    s_mul_i32 s65, s3, 2560
L_setdone:
    s_mov_b32 s26, 402653184
    s_mov_b32 s27, 0x20000
    s_movk_i32 s16, 384
    v_bfe_u32 v47, v0, 1, 3
    v_lshrrev_b32 v48, 4, v0
    v_lshl_add_u32 v48, v48, 1, v49
    v_lshlrev_b32 v63, 4, v48
    v_mad_u32_u24 v1, v47, s16, v63
    v_mad_u32_u24 v2, v44, s16, v46
    s_mul_i32 s10, s4, 12582912
    s_lshr_b32 s14, s5, 3
    s_mul_i32 s14, s14, 196608
    s_and_b32 s16, s5, 7
    s_mul_i32 s16, s16, 3072
    s_add_u32 s16, s16, s14
    s_add_u32 s10, s10, s16
    s_mul_i32 s16, s3, 24576
    s_add_u32 s10, s10, s16
    s_add_u32 s10, s10, 11010048
    ds_write_b128 v52, v[16:19] offset:49152
    ds_write_b128 v52, v[16:19] offset:50176
    s_mov_b32 s30, 402653184
    s_mov_b32 s31, 0x20000
    s_movk_i32 s42, 256
    s_mov_b32 s43, 0x20000
    s_movk_i32 s54, 1280
    s_mov_b32 s55, 0x20000
    s_mov_b32 s51, 0x20000
    s_mov_b32 s58, 0
    v_mov_b32 v40, 0
    v_mov_b32 v41, 0
    v_mov_b32 v43, 0
    v_mov_b32 v54, 0
    v_mov_b32 v57, 0
    s_mov_b32 s15, 4194304
    s_mov_b32 s67, 0x3fb8aa3b
    s_mov_b32 s66, 0x3acccccd
    v_lshlrev_b32 v47, 4, v49
    v_mov_b32 v48, 0xffff
    v_lshlrev_b32 v47, v47, v48
    v_lshrrev_b32 v48, 1, v45
    v_cmp_eq_u32 vcc, 0, v48
    s_nop 1
    v_cndmask_b32 v4, 0, v47, vcc
    v_cmp_eq_u32 vcc, 1, v48
    s_nop 1
    v_cndmask_b32 v5, 0, v47, vcc
    v_cmp_eq_u32 vcc, 2, v48
    s_nop 1
    v_cndmask_b32 v6, 0, v47, vcc
    v_cmp_eq_u32 vcc, 3, v48
    s_nop 1
    v_cndmask_b32 v7, 0, v47, vcc
    v_lshrrev_b32 v47, 5, v0
    s_lshl_b32 s16, s3, 1
    v_add_u32 v47, s16, v47
    v_mul_u32_u24 v47, 832, v47
    v_bfe_u32 v48, v0, 4, 1
    v_lshl_add_u32 v48, v45, 1, v48
    v_lshl_add_u32 v60, v48, 4, v47
    v_add_u32 v60, 52736, v60
    v_and_b32 v47, 3, v0
    v_mul_u32_u24 v47, 832, v47
    v_lshrrev_b32 v48, 2, v0
    v_lshl_add_u32 v47, v48, 4, v47
    s_and_b32 s16, s3, 3
    s_lshl_b32 s16, s16, 8
    s_add_u32 s16, s16, 52736
    s_cmp_eq_u32 s3, 7
    s_cselect_b32 s16, 52736, s16
    v_add_u32 v61, s16, v47
    s_waitcnt lgkmcnt(0)
    s_barrier
    s_cmp_eq_u32 s59, 9
    s_cbranch_scc0 L_sk1
    s_waitcnt vmcnt(0)
    s_mov_b64 exec, 1
    buffer_store_dword v16, v0, s[40:43], 0 offen sc1
    s_mov_b64 exec, -1
    s_branch L_r0done
L_sk1:
    s_waitcnt vmcnt(0)
L_r0done:
    s_cmp_eq_u32 s12, 1
    s_cbranch_scc0 L_sk2
    s_mov_b32 m0, s65
    s_mov_b32 exec_lo, 0xffffffff
    s_mov_b32 exec_hi, 0x0
    buffer_load_dwordx4 v59, s[44:47], s64 offen nt lds
    s_mov_b64 exec, -1
    s_add_u32 s65, s65, 512
    s_add_u32 s64, s64, 49152
L_sk2:
    s_cmp_eq_u32 s12, 0
    s_cbranch_scc0 L_sk3
    s_mov_b32 m0, s65
    s_add_u32 s65, s65, 2048
    buffer_load_dwordx4 v3, s[44:47], s64 offen  lds
    s_add_u32 s64, s64, 20480
    s_mov_b32 m0, s65
    s_add_u32 s65, s65, 2048
    buffer_load_dwordx4 v3, s[44:47], s64 offen  lds
    s_add_u32 s64, s64, 20480
    s_mov_b32 m0, s65
    s_add_u32 s65, s65, 2048
    buffer_load_dwordx4 v3, s[44:47], s64 offen  lds
    s_add_u32 s64, s64, 20480
    s_mov_b32 m0, s65
    s_add_u32 s65, s65, 2048
    buffer_load_dwordx4 v3, s[44:47], s64 offen  lds
    s_add_u32 s64, s64, 20480
L_sk3:
    s_mov_b32 s16, 0x3f803f80
    v_dot2_f32_bf16 v47, v8, s16, 0
    v_dot2_f32_bf16 v48, v8, v8, 0
    v_dot2_f32_bf16 v47, v9, s16, v47
    v_dot2_f32_bf16 v48, v9, v9, v48
    v_dot2_f32_bf16 v47, v10, s16, v47
    v_dot2_f32_bf16 v48, v10, v10, v48
    v_dot2_f32_bf16 v47, v11, s16, v47
    v_dot2_f32_bf16 v48, v11, v11, v48
    v_dot2_f32_bf16 v47, v12, s16, v47
    v_dot2_f32_bf16 v48, v12, v12, v48
    s_nop 1
    v_add_f32_dpp v47, v47, v47 quad_perm:[1,0,3,2] row_mask:0xf bank_mask:0xf
    v_add_f32_dpp v48, v48, v48 quad_perm:[1,0,3,2] row_mask:0xf bank_mask:0xf
    s_nop 0
    v_add_f32_dpp v47, v47, v47 quad_perm:[2,3,0,1] row_mask:0xf bank_mask:0xf
    v_add_f32_dpp v48, v48, v48 quad_perm:[2,3,0,1] row_mask:0xf bank_mask:0xf
    s_nop 0
    v_add_f32_dpp v47, v47, v47 row_half_mirror row_mask:0xf bank_mask:0xf
    v_add_f32_dpp v48, v48, v48 row_half_mirror row_mask:0xf bank_mask:0xf
    s_nop 0
    v_add_f32_dpp v47, v47, v47 row_mirror row_mask:0xf bank_mask:0xf
    v_add_f32_dpp v48, v48, v48 row_mirror row_mask:0xf bank_mask:0xf
    s_nop 0
    v_add_f32_dpp v47, v47, v47 row_bcast:15 row_mask:0xa bank_mask:0xf
    v_add_f32_dpp v48, v48, v48 row_bcast:15 row_mask:0xa bank_mask:0xf
    s_nop 0
    v_add_f32_dpp v47, v47, v47 row_bcast:31 row_mask:0xc bank_mask:0xf
    v_add_f32_dpp v48, v48, v48 row_bcast:31 row_mask:0xc bank_mask:0xf
    v_readlane_b32 s16, v47, 63
    v_readlane_b32 s17, v48, 63
    s_nop 0
    v_mov_b32 v50, s16
    v_mov_b32 v51, s17
    v_pk_mul_f32 v[50:51], v[50:51], s[66:67] op_sel_hi:[1,0]
    v_fma_f32 v51, -v50, v50, v51
    v_cvt_pk_bf16_f32 v51, 0, abs(v51)
    v_add_f32 v51, 0x37280000, v51
    v_cvt_pk_bf16_f32 v51, 0, v51
    v_sqrt_f32 v51, v51
    v_cvt_pk_bf16_f32 v50, 0, v50
    v_cvt_pk_bf16_f32 v51, 0, v51
    v_rcp_f32 v51, v51
    v_lshlrev_b32 v13, 16, v13
    v_sub_f32 v13, v13, v50
    v_cvt_pk_bf16_f32 v13, 0, v13
    v_mul_f32 v13, v13, v51
    v_cvt_pk_bf16_f32 v13, v13, v13
    v_lshlrev_b32 v14, 16, v14
    v_sub_f32 v14, v14, v50
    v_cvt_pk_bf16_f32 v14, 0, v14
    v_mul_f32 v14, v14, v51
    v_cvt_pk_bf16_f32 v14, v14, v14
    v_and_b32 v20, v13, v4
    v_and_b32 v21, v13, v5
    v_and_b32 v22, v13, v6
    v_and_b32 v23, v13, v7
    s_nop 1
    v_mfma_f32_16x16x32_bf16 v[28:31], v[20:23], v[160:163], 0
    v_mfma_f32_16x16x32_bf16 v[32:35], v[20:23], v[164:167], 0
    v_mfma_f32_16x16x32_bf16 v[36:39], v[20:23], v[168:171], 0
    v_lshrrev_b32 v48, 4, v0
    v_cmp_eq_u32 vcc, 0, v48
    s_nop 1
    v_cndmask_b32 v47, 0, v14, vcc
    v_and_b32 v176, v47, v4
    v_and_b32 v177, v47, v5
    v_and_b32 v178, v47, v6
    v_and_b32 v179, v47, v7
    s_nop 1
    v_mfma_f32_16x16x32_bf16 v[28:31], v[176:179], v[172:175], v[28:31]
    v_cmp_eq_u32 vcc, 1, v48
    s_nop 1
    v_cndmask_b32 v47, 0, v14, vcc
    v_and_b32 v180, v47, v4
    v_and_b32 v181, v47, v5
    v_and_b32 v182, v47, v6
    v_and_b32 v183, v47, v7
    s_nop 1
    v_mfma_f32_16x16x32_bf16 v[32:35], v[180:183], v[172:175], v[32:35]
    v_cmp_eq_u32 vcc, 2, v48
    s_nop 1
    v_cndmask_b32 v47, 0, v14, vcc
    v_and_b32 v184, v47, v4
    v_and_b32 v185, v47, v5
    v_and_b32 v186, v47, v6
    v_and_b32 v187, v47, v7
    s_nop 1
    v_mfma_f32_16x16x32_bf16 v[36:39], v[184:187], v[172:175], v[36:39]
    s_mov_b32 exec_lo, 0xff00ff
    s_mov_b32 exec_hi, 0xff00ff00
    ds_write_b128 v60, v[28:31] offset:0
    ds_write_b128 v60, v[32:35] offset:256
    s_nop 3
    ds_write_b128 v60, v[36:39] offset:512
    s_mov_b64 exec, -1
    s_lshl_b32 s16, s3, 2
    v_mov_b32 v47, s16
    s_mov_b64 exec, 1
    s_waitcnt lgkmcnt(0)
    ds_write_b32 v47, v47 offset:50944
    s_mov_b64 exec, -1
    s_mov_b32 s33, 0
    s_mov_b32 s34, 0
    s_waitcnt vmcnt(0)
    s_add_u32 s11, s10, 0
    buffer_load_dwordx4 v[64:67], v1, s[24:27], s11 offen offset:0 nt
    buffer_load_dwordx4 v[68:71], v1, s[24:27], s11 offen offset:128 nt
    buffer_load_dwordx4 v[72:75], v1, s[24:27], s11 offen offset:256 nt
    s_cmp_eq_u32 s12, 1
    s_cbranch_scc0 L_sk5
    s_mov_b32 m0, s65
    s_mov_b32 exec_lo, 0xff
    s_mov_b32 exec_hi, 0x0
    buffer_load_dwordx4 v59, s[44:47], s64 offen nt lds
    s_mov_b64 exec, -1
    s_add_u32 s65, s65, 128
    s_add_u32 s64, s64, 12288
    s_add_u32 s58, s58, 1
L_sk5:
    s_cmp_eq_u32 s3, 4
    s_cbranch_scc0 L_sk6
    v_lshlrev_b32 v47, 2, v45
L_cnt_rd:
    ds_read_b32 v48, v47 offset:50944
    s_waitcnt lgkmcnt(0)
    v_cmp_eq_u32 vcc, -1, v48
    s_cbranch_vccz L_cnt_ok
    s_cmp_eq_u32 s15, 0
    s_cbranch_scc1 L_cnt_ok
    s_sub_u32 s15, s15, 1
    s_sleep 2
    s_branch L_cnt_rd
L_cnt_ok:
    ds_read_b128 v[160:163], v61 offset:0
    ds_read_b128 v[164:167], v61 offset:3328
    ds_read_b128 v[168:171], v61 offset:6656
    ds_read_b128 v[172:175], v61 offset:9984
    ds_read_b128 v[176:179], v61 offset:256
    ds_read_b128 v[180:183], v61 offset:3584
    ds_read_b128 v[184:187], v61 offset:6912
    ds_read_b128 v[188:191], v61 offset:10240
    ds_read_b128 v[192:195], v61 offset:512
    ds_read_b128 v[196:199], v61 offset:3840
    ds_read_b128 v[200:203], v61 offset:7168
    ds_read_b128 v[204:207], v61 offset:10496
    s_waitcnt lgkmcnt(0)
    v_pk_add_f32 v[160:161], v[160:161], v[164:165]
    v_pk_add_f32 v[162:163], v[162:163], v[166:167]
    v_pk_add_f32 v[160:161], v[160:161], v[168:169]
    v_pk_add_f32 v[162:163], v[162:163], v[170:171]
    v_pk_add_f32 v[160:161], v[160:161], v[172:173]
    v_pk_add_f32 v[162:163], v[162:163], v[174:175]
    s_nop 0
    v_add_f32_dpp v160, v160, v160 quad_perm:[1,0,3,2] row_mask:0xf bank_mask:0xf
    v_add_f32_dpp v161, v161, v161 quad_perm:[1,0,3,2] row_mask:0xf bank_mask:0xf
    v_add_f32_dpp v162, v162, v162 quad_perm:[1,0,3,2] row_mask:0xf bank_mask:0xf
    v_add_f32_dpp v163, v163, v163 quad_perm:[1,0,3,2] row_mask:0xf bank_mask:0xf
    v_add_f32_dpp v160, v160, v160 quad_perm:[2,3,0,1] row_mask:0xf bank_mask:0xf
    v_add_f32_dpp v161, v161, v161 quad_perm:[2,3,0,1] row_mask:0xf bank_mask:0xf
    v_add_f32_dpp v162, v162, v162 quad_perm:[2,3,0,1] row_mask:0xf bank_mask:0xf
    v_add_f32_dpp v163, v163, v163 quad_perm:[2,3,0,1] row_mask:0xf bank_mask:0xf
    v_pk_add_f32 v[176:177], v[176:177], v[180:181]
    v_pk_add_f32 v[178:179], v[178:179], v[182:183]
    v_pk_add_f32 v[176:177], v[176:177], v[184:185]
    v_pk_add_f32 v[178:179], v[178:179], v[186:187]
    v_pk_add_f32 v[176:177], v[176:177], v[188:189]
    v_pk_add_f32 v[178:179], v[178:179], v[190:191]
    s_nop 0
    v_add_f32_dpp v176, v176, v176 quad_perm:[1,0,3,2] row_mask:0xf bank_mask:0xf
    v_add_f32_dpp v177, v177, v177 quad_perm:[1,0,3,2] row_mask:0xf bank_mask:0xf
    v_add_f32_dpp v178, v178, v178 quad_perm:[1,0,3,2] row_mask:0xf bank_mask:0xf
    v_add_f32_dpp v179, v179, v179 quad_perm:[1,0,3,2] row_mask:0xf bank_mask:0xf
    v_add_f32_dpp v176, v176, v176 quad_perm:[2,3,0,1] row_mask:0xf bank_mask:0xf
    v_add_f32_dpp v177, v177, v177 quad_perm:[2,3,0,1] row_mask:0xf bank_mask:0xf
    v_add_f32_dpp v178, v178, v178 quad_perm:[2,3,0,1] row_mask:0xf bank_mask:0xf
    v_add_f32_dpp v179, v179, v179 quad_perm:[2,3,0,1] row_mask:0xf bank_mask:0xf
    v_pk_add_f32 v[192:193], v[192:193], v[196:197]
    v_pk_add_f32 v[194:195], v[194:195], v[198:199]
    v_pk_add_f32 v[192:193], v[192:193], v[200:201]
    v_pk_add_f32 v[194:195], v[194:195], v[202:203]
    v_pk_add_f32 v[192:193], v[192:193], v[204:205]
    v_pk_add_f32 v[194:195], v[194:195], v[206:207]
    s_nop 0
    v_add_f32_dpp v192, v192, v192 quad_perm:[1,0,3,2] row_mask:0xf bank_mask:0xf
    v_add_f32_dpp v193, v193, v193 quad_perm:[1,0,3,2] row_mask:0xf bank_mask:0xf
    v_add_f32_dpp v194, v194, v194 quad_perm:[1,0,3,2] row_mask:0xf bank_mask:0xf
    v_add_f32_dpp v195, v195, v195 quad_perm:[1,0,3,2] row_mask:0xf bank_mask:0xf
    v_add_f32_dpp v192, v192, v192 quad_perm:[2,3,0,1] row_mask:0xf bank_mask:0xf
    v_add_f32_dpp v193, v193, v193 quad_perm:[2,3,0,1] row_mask:0xf bank_mask:0xf
    v_add_f32_dpp v194, v194, v194 quad_perm:[2,3,0,1] row_mask:0xf bank_mask:0xf
    v_add_f32_dpp v195, v195, v195 quad_perm:[2,3,0,1] row_mask:0xf bank_mask:0xf
    s_mov_b32 s8, 0x22222222
    s_mov_b32 s9, 0x22222222
    v_cndmask_b32 v160, v160, v176, s[8:9]
    v_cndmask_b32 v161, v161, v177, s[8:9]
    v_cndmask_b32 v162, v162, v178, s[8:9]
    v_cndmask_b32 v163, v163, v179, s[8:9]
    s_mov_b32 s8, 0x44444444
    s_mov_b32 s9, 0x44444444
    v_cndmask_b32 v160, v160, v192, s[8:9]
    v_cndmask_b32 v161, v161, v193, s[8:9]
    v_cndmask_b32 v162, v162, v194, s[8:9]
    v_cndmask_b32 v163, v163, v195, s[8:9]
    v_lshrrev_b32 v47, 2, v0
    v_sub_u32 v47, v0, v47
    v_lshlrev_b32 v47, 4, v47
    s_mov_b32 exec_lo, 0x77777777
    s_mov_b32 exec_hi, 0x77777777
    buffer_store_dwordx4 v[160:163], v47, s[36:39], s57 offen sc1
    s_mov_b64 exec, -1
    v_cmp_lt_u32 vcc, 23, v0
    v_mov_b32 v48, 97920
    s_nop 0
    v_cndmask_b32 v48, 0, v48, vcc
    v_add_u32 v48, v48, v52
    s_mov_b32 exec_hi, 0xffff
    buffer_store_dwordx4 v[16:19], v48, s[36:39], s13 offen sc1
    s_mov_b64 exec, -1
    s_cmp_eq_u32 s12, 0
    s_cbranch_scc0 L_clf
    v_lshrrev_b32 v48, 1, v44
    v_mul_u32_u24 v48, 65536, v48
    v_and_b32 v47, 1, v44
    v_mul_u32_u24 v47, 8192, v47
    v_add_u32 v47, v47, v48
    v_add_u32 v47, v47, v46
    s_lshr_b32 s14, s69, 2
    s_mul_i32 s14, s14, 16384
    s_and_b32 s16, s69, 3
    s_mul_i32 s16, s16, 1280
    s_add_u32 s16, s16, s14
    s_lshl_b32 s14, s68, 7
    s_add_u32 s16, s16, s14
    s_add_u32 s16, s16, 32768
    s_mov_b32 exec_lo, 0xffffffff
    s_mov_b32 exec_hi, 0xffffffff
    buffer_store_dwordx4 v[16:19], v47, s[36:39], s16 offen sc1
    s_mov_b64 exec, -1
    s_branch L_cle
L_clf:
    v_lshrrev_b32 v47, 2, v44
    v_lshlrev_b32 v47, 16, v47
    v_and_b32 v48, 1, v44
    v_lshl_add_u32 v47, v48, 15, v47
    v_and_b32 v48, 2, v44
    v_lshl_add_u32 v47, v48, 12, v47
    v_add_u32 v47, v47, v46
    s_lshr_b32 s14, s68, 6
    s_mul_i32 s14, s14, 16384
    s_and_b32 s16, s68, 63
    s_mul_i32 s16, s16, 128
    s_add_u32 s16, s16, s14
    s_add_u32 s16, s16, 294912
    s_add_u32 s17, s16, 131072
    s_add_u32 s18, s16, 262144
    buffer_store_dwordx4 v[16:19], v47, s[36:39], s16 offen sc1
    buffer_store_dwordx4 v[16:19], v47, s[36:39], s17 offen sc1
    s_mov_b32 exec_hi, 0
    buffer_store_dwordx4 v[16:19], v47, s[36:39], s18 offen sc1
    s_mov_b64 exec, -1
    s_add_u32 s58, s58, 2
L_cle:
    s_add_u32 s58, s58, 3
L_sk6:
    s_cmp_eq_u32 s59, 9
    s_cbranch_scc0 L_sk7
    s_waitcnt lgkmcnt(0)
    s_mov_b32 s16, 0
    s_mov_b32 s17, 0
    s_load_dword s16, s[36:37], 16384
    s_load_dword s17, s[36:37], 24576
    s_waitcnt lgkmcnt(1)
    s_sub_u32 s18, s17, s16
    s_add_u32 s33, s33, s18
    s_waitcnt lgkmcnt(0)
L_sk7:
    s_waitcnt vmcnt(6)
    s_cmp_ge_u32 s58, 6
    s_cbranch_scc1 L_ld8
    s_waitcnt vmcnt(5)
    s_cmp_ge_u32 s58, 5
    s_cbranch_scc1 L_ld8
    s_waitcnt vmcnt(4)
    s_cmp_ge_u32 s58, 4
    s_cbranch_scc1 L_ld8
    s_waitcnt vmcnt(3)
    s_cmp_ge_u32 s58, 3
    s_cbranch_scc1 L_ld8
    s_waitcnt vmcnt(2)
    s_cmp_ge_u32 s58, 2
    s_cbranch_scc1 L_ld8
    s_waitcnt vmcnt(1)
    s_cmp_ge_u32 s58, 1
    s_cbranch_scc1 L_ld8
    s_waitcnt vmcnt(0)
L_ld8:
    s_mov_b32 s58, 0
    s_add_u32 s11, s10, 393216
    buffer_load_dwordx4 v[76:79], v1, s[24:27], s11 offen offset:0 nt
    buffer_load_dwordx4 v[80:83], v1, s[24:27], s11 offen offset:128 nt
    buffer_load_dwordx4 v[84:87], v1, s[24:27], s11 offen offset:256 nt
    s_cmp_eq_u32 s12, 1
    s_cbranch_scc0 L_sk9
    s_mov_b32 m0, s65
    s_mov_b32 exec_lo, 0xff
    s_mov_b32 exec_hi, 0x0
    buffer_load_dwordx4 v59, s[44:47], s64 offen nt lds
    s_mov_b64 exec, -1
    s_add_u32 s65, s65, 128
    s_add_u32 s64, s64, 12288
    s_add_u32 s58, s58, 1
L_sk9:
    s_cmp_eq_u32 s3, 4
    s_cbranch_scc0 L_sk10
    buffer_load_dword v44, v43, s[40:43], 0 offen sc1
L_sk10:
    s_cmp_eq_u32 s59, 9
    s_cbranch_scc0 L_sk11
    s_waitcnt lgkmcnt(0)
    s_mov_b32 s16, 0
    s_mov_b32 s17, 0
    s_load_dword s17, s[36:37], 24704
    s_load_dword s16, s[36:37], 16512
    s_waitcnt lgkmcnt(1)
    s_sub_u32 s18, s17, s16
    s_add_u32 s33, s33, s18
    s_waitcnt lgkmcnt(0)
L_sk11:
    s_cmp_eq_u32 s3, 4
    s_cselect_b32 s58, 0, s58
    s_waitcnt vmcnt(1)
    s_cmp_ge_u32 s58, 1
    s_cbranch_scc1 L_ld12
    s_waitcnt vmcnt(0)
L_ld12:
    s_mov_b32 s58, 0
    s_add_u32 s11, s10, 786432
    buffer_load_dwordx4 v[88:91], v1, s[24:27], s11 offen offset:0 nt
    buffer_load_dwordx4 v[92:95], v1, s[24:27], s11 offen offset:128 nt
    buffer_load_dwordx4 v[96:99], v1, s[24:27], s11 offen offset:256 nt
    s_cmp_eq_u32 s12, 1
    s_cbranch_scc0 L_sk13
    s_mov_b32 m0, s65
    s_mov_b32 exec_lo, 0xff
    s_mov_b32 exec_hi, 0x0
    buffer_load_dwordx4 v59, s[44:47], s64 offen nt lds
    s_mov_b64 exec, -1
    s_add_u32 s65, s65, 128
    s_add_u32 s64, s64, 12288
    s_add_u32 s58, s58, 1
L_sk13:
    s_cmp_eq_u32 s3, 4
    s_cbranch_scc0 L_sk14
    s_branch L_go_chk
L_go_again:
    s_cmp_lg_u32 s15, 0
    s_cbranch_scc0 L_go_ok
    s_sub_u32 s15, s15, 1
    s_sleep 4
    s_mov_b64 exec, vcc
    buffer_load_dword v44, v43, s[40:43], 0 offen sc1
    s_mov_b64 exec, -1
    s_waitcnt vmcnt(0)
L_go_chk:
    v_cmp_eq_u32 vcc, 0, v44
    s_cbranch_vccnz L_go_again
L_go_ok:
    s_lshl_b32 s17, s6, 7
    s_add_u32 s17, s17, 0
    s_lshl2_add_u32 s16, s7, s17
    s_getreg_b32 s17, hwreg(HW_REG_XCC_ID, 0, 4)
    v_mov_b32 v44, s17
    s_lshl_b32 s17, s4, 7
    s_add_u32 s17, s17, 0
    v_lshrrev_b32 v47, 3, v0
    v_mul_u32_u24 v47, 2048, v47
    v_and_b32 v41, 7, v0
    v_mul_u32_u24 v41, 4, v41
    v_add_u32 v41, v41, v47
    s_mov_b64 exec, 1
    buffer_store_dword v44, v43, s[36:39], s16 offen sc1
    s_add_u32 s58, s58, 1
    s_mov_b64 exec, -1
L_sk14:
    s_cmp_eq_u32 s59, 9
    s_cbranch_scc0 L_sk15
    s_waitcnt lgkmcnt(0)
    s_mov_b32 s16, 0
    s_mov_b32 s17, 0
    s_load_dword s16, s[36:37], 16640
    s_load_dword s17, s[36:37], 24832
    s_waitcnt lgkmcnt(1)
    s_sub_u32 s18, s17, s16
    s_add_u32 s33, s33, s18
    s_waitcnt lgkmcnt(0)
L_sk15:
    s_waitcnt vmcnt(2)
    s_cmp_ge_u32 s58, 2
    s_cbranch_scc1 L_ld16
    s_waitcnt vmcnt(1)
    s_cmp_ge_u32 s58, 1
    s_cbranch_scc1 L_ld16
    s_waitcnt vmcnt(0)
L_ld16:
    s_mov_b32 s58, 0
    s_add_u32 s11, s10, 1179648
    buffer_load_dwordx4 v[100:103], v1, s[24:27], s11 offen offset:0 nt
    buffer_load_dwordx4 v[104:107], v1, s[24:27], s11 offen offset:128 nt
    buffer_load_dwordx4 v[108:111], v1, s[24:27], s11 offen offset:256 nt
    s_cmp_eq_u32 s12, 1
    s_cbranch_scc0 L_sk17
    s_mov_b32 m0, s65
    s_mov_b32 exec_lo, 0xff
    s_mov_b32 exec_hi, 0x0
    buffer_load_dwordx4 v59, s[44:47], s64 offen nt lds
    s_mov_b64 exec, -1
    s_add_u32 s65, s65, 128
    s_add_u32 s64, s64, 12288
    s_add_u32 s58, s58, 1
L_sk17:
    s_cmp_eq_u32 s59, 9
    s_cbranch_scc0 L_sk18
    s_waitcnt lgkmcnt(0)
    s_mov_b32 s16, 0
    s_mov_b32 s17, 0
    s_load_dword s17, s[36:37], 24960
    s_load_dword s16, s[36:37], 16768
    s_waitcnt lgkmcnt(1)
    s_sub_u32 s18, s17, s16
    s_add_u32 s33, s33, s18
    s_waitcnt lgkmcnt(0)
L_sk18:
    s_waitcnt vmcnt(1)
    s_cmp_ge_u32 s58, 1
    s_cbranch_scc1 L_ld19
    s_waitcnt vmcnt(0)
L_ld19:
    s_mov_b32 s58, 0
    s_add_u32 s11, s10, 201326592
    buffer_load_dwordx4 v[112:115], v1, s[24:27], s11 offen offset:0 nt
    buffer_load_dwordx4 v[116:119], v1, s[24:27], s11 offen offset:128 nt
    buffer_load_dwordx4 v[120:123], v1, s[24:27], s11 offen offset:256 nt
    s_cmp_eq_u32 s12, 1
    s_cbranch_scc0 L_sk20
    s_mov_b32 m0, s65
    s_mov_b32 exec_lo, 0xff
    s_mov_b32 exec_hi, 0x0
    buffer_load_dwordx4 v59, s[44:47], s64 offen nt lds
    s_mov_b64 exec, -1
    s_add_u32 s65, s65, 128
    s_add_u32 s64, s64, 12288
    s_add_u32 s58, s58, 1
L_sk20:
    s_cmp_eq_u32 s3, 4
    s_cbranch_scc0 L_sk21
    s_mov_b64 exec, 0xffff
    buffer_load_dword v44, v41, s[36:39], s17 offen sc1
    s_add_u32 s58, s58, 1
    s_mov_b64 exec, -1
L_sk21:
    s_cmp_eq_u32 s59, 9
    s_cbranch_scc0 L_sk22
    s_waitcnt lgkmcnt(0)
    s_mov_b32 s16, 0
    s_mov_b32 s17, 0
    s_load_dword s16, s[36:37], 16896
    s_load_dword s17, s[36:37], 25088
    s_waitcnt lgkmcnt(1)
    s_sub_u32 s18, s17, s16
    s_add_u32 s33, s33, s18
    s_waitcnt lgkmcnt(0)
L_sk22:
    s_waitcnt vmcnt(2)
    s_cmp_ge_u32 s58, 2
    s_cbranch_scc1 L_ld23
    s_waitcnt vmcnt(1)
    s_cmp_ge_u32 s58, 1
    s_cbranch_scc1 L_ld23
    s_waitcnt vmcnt(0)
L_ld23:
    s_mov_b32 s58, 0
    s_add_u32 s11, s10, 201719808
    buffer_load_dwordx4 v[124:127], v1, s[24:27], s11 offen offset:0 nt
    buffer_load_dwordx4 v[128:131], v1, s[24:27], s11 offen offset:128 nt
    buffer_load_dwordx4 v[132:135], v1, s[24:27], s11 offen offset:256 nt
    s_cmp_eq_u32 s3, 4
    s_cbranch_scc0 L_sk24
    s_waitcnt vmcnt(3)
L_sk24:
    s_cmp_eq_u32 s12, 1
    s_cbranch_scc0 L_sk25
    s_mov_b32 m0, s65
    s_mov_b32 exec_lo, 0xff
    s_mov_b32 exec_hi, 0x0
    buffer_load_dwordx4 v59, s[44:47], s64 offen nt lds
    s_mov_b64 exec, -1
    s_add_u32 s65, s65, 128
    s_add_u32 s64, s64, 12288
    s_add_u32 s58, s58, 1
L_sk25:
    s_cmp_eq_u32 s3, 4
    s_cbranch_scc0 L_sk26
    s_mov_b64 exec, 0xffff
    s_branch L_flag_chk
L_flag_again:
    s_cmp_lg_u32 s15, 0
    s_cbranch_scc0 L_flag_ok
    s_sub_u32 s15, s15, 1
    s_sleep 4
    s_mov_b64 exec, vcc
    buffer_load_dword v44, v41, s[36:39], s17 offen sc1
    s_waitcnt vmcnt(0)
L_flag_chk:
    v_cmp_eq_u32 vcc, -1, v44
    s_cbranch_vccnz L_flag_again
L_flag_ok:
    s_mov_b64 exec, -1
    s_mov_b32 exec_hi, 0xffff
    s_mul_i32 s16, s4, 6144
    s_add_u32 s16, s16, 622592
    buffer_load_dwordx4 v[192:195], v52, s[36:39], s16 offen offset:0 sc1
    buffer_load_dwordx4 v[196:199], v52, s[36:39], s16 offen offset:768 sc1
    buffer_load_dwordx4 v[200:203], v52, s[36:39], s16 offen offset:1536 sc1
    buffer_load_dwordx4 v[204:207], v52, s[36:39], s16 offen offset:2304 sc1
    s_add_u32 s16, s16, 3072
    buffer_load_dwordx4 v[208:211], v52, s[36:39], s16 offen offset:0 sc1
    buffer_load_dwordx4 v[212:215], v52, s[36:39], s16 offen offset:768 sc1
    buffer_load_dwordx4 v[216:219], v52, s[36:39], s16 offen offset:1536 sc1
    buffer_load_dwordx4 v[220:223], v52, s[36:39], s16 offen offset:2304 sc1
    s_mul_i32 s16, s4, 6144
    s_add_u32 s16, s16, 720896
    buffer_load_dwordx4 v[224:227], v52, s[36:39], s16 offen offset:0 sc1
    buffer_load_dwordx4 v[228:231], v52, s[36:39], s16 offen offset:768 sc1
    buffer_load_dwordx4 v[232:235], v52, s[36:39], s16 offen offset:1536 sc1
    buffer_load_dwordx4 v[236:239], v52, s[36:39], s16 offen offset:2304 sc1
    s_add_u32 s16, s16, 3072
    buffer_load_dwordx4 v[240:243], v52, s[36:39], s16 offen offset:0 sc1
    buffer_load_dwordx4 v[244:247], v52, s[36:39], s16 offen offset:768 sc1
    buffer_load_dwordx4 v[248:251], v52, s[36:39], s16 offen offset:1536 sc1
    buffer_load_dwordx4 v[252:255], v52, s[36:39], s16 offen offset:2304 sc1
    s_add_u32 s58, s58, 16
    s_mov_b64 exec, -1
L_sk26:
    s_cmp_eq_u32 s59, 9
    s_cbranch_scc0 L_sk27
    s_waitcnt lgkmcnt(0)
    s_mov_b32 s16, 0
    s_mov_b32 s17, 0
    s_load_dword s17, s[36:37], 25216
    s_load_dword s16, s[36:37], 17024
    s_waitcnt lgkmcnt(1)
    s_sub_u32 s18, s17, s16
    s_add_u32 s33, s33, s18
    s_waitcnt lgkmcnt(0)
L_sk27:
    s_waitcnt vmcnt(17)
    s_cmp_ge_u32 s58, 17
    s_cbranch_scc1 L_ld28
    s_waitcnt vmcnt(16)
    s_cmp_ge_u32 s58, 16
    s_cbranch_scc1 L_ld28
    s_waitcnt vmcnt(1)
    s_cmp_ge_u32 s58, 1
    s_cbranch_scc1 L_ld28
    s_waitcnt vmcnt(0)
L_ld28:
    s_mov_b32 s58, 0
    s_add_u32 s11, s10, 202113024
    buffer_load_dwordx4 v[136:139], v1, s[24:27], s11 offen offset:0 nt
    buffer_load_dwordx4 v[140:143], v1, s[24:27], s11 offen offset:128 nt
    buffer_load_dwordx4 v[144:147], v1, s[24:27], s11 offen offset:256 nt
    s_cmp_eq_u32 s3, 4
    s_cbranch_scc0 L_sk29
    s_waitcnt vmcnt(3)
L_sk29:
    s_cmp_eq_u32 s12, 1
    s_cbranch_scc0 L_sk30
    s_mov_b32 m0, s65
    s_mov_b32 exec_lo, 0xff
    s_mov_b32 exec_hi, 0x0
    buffer_load_dwordx4 v59, s[44:47], s64 offen nt lds
    s_mov_b64 exec, -1
    s_add_u32 s65, s65, 128
    s_add_u32 s64, s64, 12288
    s_add_u32 s58, s58, 1
L_sk30:
    s_cmp_eq_u32 s3, 4
    s_cbranch_scc0 L_sk31
    v_mul_u32_u24 v46, 43, v0
    v_lshrrev_b32 v46, 7, v46
    v_mul_u32_u24 v46, 376, v46
    v_lshlrev_b32 v47, 7, v0
    v_sub_u32 v46, v47, v46
    s_mov_b32 exec_hi, 0xffff
    v_pk_add_f32 v[192:193], v[192:193], v[196:197]
    v_pk_add_f32 v[194:195], v[194:195], v[198:199]
    v_pk_add_f32 v[192:193], v[192:193], v[200:201]
    v_pk_add_f32 v[194:195], v[194:195], v[202:203]
    v_pk_add_f32 v[192:193], v[192:193], v[204:205]
    v_pk_add_f32 v[194:195], v[194:195], v[206:207]
    v_pk_add_f32 v[192:193], v[192:193], v[208:209]
    v_pk_add_f32 v[194:195], v[194:195], v[210:211]
    v_pk_add_f32 v[192:193], v[192:193], v[212:213]
    v_pk_add_f32 v[194:195], v[194:195], v[214:215]
    v_pk_add_f32 v[192:193], v[192:193], v[216:217]
    v_pk_add_f32 v[194:195], v[194:195], v[218:219]
    v_pk_add_f32 v[192:193], v[192:193], v[220:221]
    v_pk_add_f32 v[194:195], v[194:195], v[222:223]
    v_cvt_pk_bf16_f32 v192, v192, v193
    v_cvt_pk_bf16_f32 v193, v194, v195
    ds_write_b64 v46, v[192:193] offset:49152
    v_pk_add_f32 v[224:225], v[224:225], v[228:229]
    v_pk_add_f32 v[226:227], v[226:227], v[230:231]
    v_pk_add_f32 v[224:225], v[224:225], v[232:233]
    v_pk_add_f32 v[226:227], v[226:227], v[234:235]
    v_pk_add_f32 v[224:225], v[224:225], v[236:237]
    v_pk_add_f32 v[226:227], v[226:227], v[238:239]
    v_pk_add_f32 v[224:225], v[224:225], v[240:241]
    v_pk_add_f32 v[226:227], v[226:227], v[242:243]
    v_pk_add_f32 v[224:225], v[224:225], v[244:245]
    v_pk_add_f32 v[226:227], v[226:227], v[246:247]
    v_pk_add_f32 v[224:225], v[224:225], v[248:249]
    v_pk_add_f32 v[226:227], v[226:227], v[250:251]
    v_pk_add_f32 v[224:225], v[224:225], v[252:253]
    v_pk_add_f32 v[226:227], v[226:227], v[254:255]
    v_cvt_pk_bf16_f32 v224, v224, v225
    v_cvt_pk_bf16_f32 v225, v226, v227
    ds_write_b64 v46, v[224:225] offset:49536
    s_mov_b64 exec, -1
L_sk31:
    s_cmp_eq_u32 s59, 9
    s_cbranch_scc0 L_sk32
    s_waitcnt lgkmcnt(0)
    s_mov_b32 s16, 0
    s_mov_b32 s17, 0
    s_load_dword s16, s[36:37], 17152
    s_load_dword s17, s[36:37], 25344
    s_waitcnt lgkmcnt(1)
    s_sub_u32 s18, s17, s16
    s_add_u32 s33, s33, s18
    s_waitcnt lgkmcnt(0)
L_sk32:
    s_cmp_eq_u32 s59, 9
    s_cbranch_scc0 L_sk33
    v_lshlrev_b32 v41, 4, v49
    v_add_u32 v41, 0, v41
    v_lshrrev_b32 v40, 1, v0
    v_lshl_add_u32 v40, v40, 7, v41
    buffer_load_dwordx4 v[24:27], v40, s[36:39], 0 offen sc1
    buffer_load_dwordx4 v[28:31], v41, s[36:39], 0 offen sc1
    s_add_u32 s58, s58, 2
L_sk33:
    s_waitcnt vmcnt(3)
    s_cmp_ge_u32 s58, 3
    s_cbranch_scc1 L_ld34
    s_waitcnt vmcnt(2)
    s_cmp_ge_u32 s58, 2
    s_cbranch_scc1 L_ld34
    s_waitcnt vmcnt(1)
    s_cmp_ge_u32 s58, 1
    s_cbranch_scc1 L_ld34
    s_waitcnt vmcnt(0)
L_ld34:
    s_mov_b32 s58, 0
    s_add_u32 s11, s10, 202506240
    buffer_load_dwordx4 v[148:151], v1, s[24:27], s11 offen offset:0 nt
    buffer_load_dwordx4 v[152:155], v1, s[24:27], s11 offen offset:128 nt
    buffer_load_dwordx4 v[156:159], v1, s[24:27], s11 offen offset:256 nt
    s_cmp_eq_u32 s59, 9
    s_cbranch_scc0 L_sk35
    s_waitcnt vmcnt(3)
L_sk35:
    s_cmp_eq_u32 s12, 1
    s_cbranch_scc0 L_sk36
    s_mov_b32 m0, s65
    s_mov_b32 exec_lo, 0xff
    s_mov_b32 exec_hi, 0x0
    buffer_load_dwordx4 v59, s[44:47], s64 offen nt lds
    s_mov_b64 exec, -1
    s_add_u32 s65, s65, 128
    s_add_u32 s64, s64, 12288
    s_add_u32 s58, s58, 1
L_sk36:
    s_cmp_eq_u32 s59, 9
    s_cbranch_scc0 L_sk37
    s_branch L_all_chk
L_all_again:
    s_cmp_lg_u32 s15, 0
    s_cbranch_scc0 L_all_ok
    s_sub_u32 s15, s15, 1
    s_sleep 4
    s_mov_b64 exec, vcc
    buffer_load_dwordx4 v[24:27], v40, s[36:39], 0 offen sc1
    buffer_load_dwordx4 v[28:31], v41, s[36:39], 0 offen sc1
    s_mov_b64 exec, -1
    s_waitcnt vmcnt(0)
L_all_chk:
    v_max3_u32 v44, v24, v25, v26
    v_max3_u32 v44, v44, v27, v28
    v_max3_u32 v44, v44, v29, v30
    v_max_u32 v44, v44, v31
    v_cmp_eq_u32 vcc, -1, v44
    s_cbranch_vccnz L_all_again
L_all_ok:
    v_xor_b32 v24, v24, v28
    v_xor_b32 v25, v25, v29
    v_xor_b32 v26, v26, v30
    v_xor_b32 v27, v27, v31
    v_or3_b32 v24, v24, v25, v26
    v_or_b32 v24, v24, v27
    v_cmp_ne_u32 vcc, 0, v24
    s_cmp_eq_u64 vcc, 0
    s_cselect_b32 s16, 0, 0x80000000
    s_cmp_gt_i32 s33, 0
    s_cselect_b32 s17, 1, 2
    s_or_b32 s16, s16, s17
    v_mov_b32 v24, s16
    s_mov_b64 exec, 1
    buffer_store_dword v24, v43, s[40:43], 0 offen offset:128 sc1
    s_add_u32 s58, s58, 1
    s_mov_b64 exec, -1
L_sk37:
    s_waitcnt vmcnt(2)
    s_cmp_ge_u32 s58, 2
    s_cbranch_scc1 L_ld38
    s_waitcnt vmcnt(1)
    s_cmp_ge_u32 s58, 1
    s_cbranch_scc1 L_ld38
    s_waitcnt vmcnt(0)
L_ld38:
    s_mov_b32 s58, 0
    s_add_u32 s11, s10, 201326592
    buffer_load_dwordx4 v[160:163], v2, s[28:31], s11 offen offset:0 nt
    buffer_load_dwordx4 v[164:167], v2, s[28:31], s11 offen offset:128 nt
    buffer_load_dwordx4 v[168:171], v2, s[28:31], s11 offen offset:256 nt
L_q_rd:
    ds_read_b128 v[8:11], v63 offset:49152
    ds_read_b128 v[12:15], v63 offset:49280
    ds_read_b128 v[16:19], v63 offset:49408
    ds_read_b128 v[28:31], v63 offset:49536
    ds_read_b128 v[32:35], v63 offset:49664
    ds_read_b128 v[36:39], v63 offset:49792
    s_waitcnt lgkmcnt(0)
    v_max3_u32 v44, v8, v9, v10
    v_max3_u32 v44, v44, v11, v12
    v_max3_u32 v44, v44, v13, v14
    v_max3_u32 v44, v44, v15, v16
    v_max3_u32 v44, v44, v17, v18
    v_max3_u32 v44, v44, v19, v28
    v_max3_u32 v44, v44, v29, v30
    v_max3_u32 v44, v44, v31, v32
    v_max3_u32 v44, v44, v33, v34
    v_max3_u32 v44, v44, v35, v36
    v_max3_u32 v44, v44, v37, v38
    v_max_u32 v44, v44, v39
    v_cmp_eq_u32 vcc, -1, v44
    s_cbranch_vccz L_q_ok
    s_cmp_eq_u32 s15, 0
    s_cbranch_scc1 L_q_ok
    s_sub_u32 s15, s15, 1
    s_sleep 2
    s_branch L_q_rd
L_q_ok:
    s_mov_b32 s8, 0xff00ff00
    s_mov_b32 s9, 0xff00ff00
    s_mov_b32 s16, 0xaaaaaaaa
    s_mov_b32 s17, 0xaaaaaaaa
    v_mfma_f32_16x16x32_bf16 v[44:47], v[64:67], v[8:11], 0
    v_mfma_f32_16x16x32_bf16 v[44:47], v[68:71], v[12:15], v[44:47]
    v_mfma_f32_16x16x32_bf16 v[44:47], v[72:75], v[16:19], v[44:47]
    v_mfma_f32_16x16x32_bf16 v[48:51], v[76:79], v[8:11], 0
    v_mfma_f32_16x16x32_bf16 v[48:51], v[80:83], v[12:15], v[48:51]
    v_mfma_f32_16x16x32_bf16 v[48:51], v[84:87], v[16:19], v[48:51]
    s_nop 4
    v_cndmask_b32 v44, v44, v46, s[8:9]
    v_cndmask_b32 v45, v45, v47, s[8:9]
    v_cndmask_b32 v44, v44, v45, s[16:17]
    s_nop 1
    v_add_f32_dpp v44, v44, v44 quad_perm:[1,0,3,2] row_mask:0xf bank_mask:0xf
    v_cvt_pk_bf16_f32 v44, 0, v44
    v_mul_f32 v44, 0x3d93cd3a, v44
    v_cvt_pk_bf16_f32 v20, 0, v44
    v_mfma_f32_16x16x32_bf16 v[44:47], v[88:91], v[8:11], 0
    v_mfma_f32_16x16x32_bf16 v[44:47], v[92:95], v[12:15], v[44:47]
    v_mfma_f32_16x16x32_bf16 v[44:47], v[96:99], v[16:19], v[44:47]
    v_cndmask_b32 v48, v48, v50, s[8:9]
    v_cndmask_b32 v49, v49, v51, s[8:9]
    v_cndmask_b32 v48, v48, v49, s[16:17]
    s_nop 1
    v_add_f32_dpp v48, v48, v48 quad_perm:[1,0,3,2] row_mask:0xf bank_mask:0xf
    v_cvt_pk_bf16_f32 v48, 0, v48
    v_mul_f32 v48, 0x3d93cd3a, v48
    v_cvt_pk_bf16_f32 v21, 0, v48
    v_mfma_f32_16x16x32_bf16 v[48:51], v[100:103], v[8:11], 0
    v_mfma_f32_16x16x32_bf16 v[48:51], v[104:107], v[12:15], v[48:51]
    v_mfma_f32_16x16x32_bf16 v[48:51], v[108:111], v[16:19], v[48:51]
    v_cndmask_b32 v44, v44, v46, s[8:9]
    v_cndmask_b32 v45, v45, v47, s[8:9]
    v_cndmask_b32 v44, v44, v45, s[16:17]
    s_nop 1
    v_add_f32_dpp v44, v44, v44 quad_perm:[1,0,3,2] row_mask:0xf bank_mask:0xf
    v_cvt_pk_bf16_f32 v44, 0, v44
    v_mul_f32 v44, 0x3d93cd3a, v44
    v_cvt_pk_bf16_f32 v22, 0, v44
    v_mfma_f32_16x16x32_bf16 v[44:47], v[112:115], v[28:31], 0
    v_mfma_f32_16x16x32_bf16 v[44:47], v[116:119], v[32:35], v[44:47]
    v_mfma_f32_16x16x32_bf16 v[44:47], v[120:123], v[36:39], v[44:47]
    v_cndmask_b32 v48, v48, v50, s[8:9]
    v_cndmask_b32 v49, v49, v51, s[8:9]
    v_cndmask_b32 v48, v48, v49, s[16:17]
    s_nop 1
    v_add_f32_dpp v48, v48, v48 quad_perm:[1,0,3,2] row_mask:0xf bank_mask:0xf
    v_cvt_pk_bf16_f32 v48, 0, v48
    v_mul_f32 v48, 0x3d93cd3a, v48
    v_cvt_pk_bf16_f32 v23, 0, v48
    v_mfma_f32_16x16x32_bf16 v[48:51], v[124:127], v[28:31], 0
    v_mfma_f32_16x16x32_bf16 v[48:51], v[128:131], v[32:35], v[48:51]
    v_mfma_f32_16x16x32_bf16 v[48:51], v[132:135], v[36:39], v[48:51]
    v_cndmask_b32 v44, v44, v46, s[8:9]
    v_cndmask_b32 v45, v45, v47, s[8:9]
    v_cndmask_b32 v44, v44, v45, s[16:17]
    s_nop 1
    v_add_f32_dpp v44, v44, v44 quad_perm:[1,0,3,2] row_mask:0xf bank_mask:0xf
    v_cvt_pk_bf16_f32 v44, 0, v44
    v_mul_f32 v44, 0x3d93cd3a, v44
    v_cvt_pk_bf16_f32 v24, 0, v44
    v_mfma_f32_16x16x32_bf16 v[44:47], v[136:139], v[28:31], 0
    v_mfma_f32_16x16x32_bf16 v[44:47], v[140:143], v[32:35], v[44:47]
    v_mfma_f32_16x16x32_bf16 v[44:47], v[144:147], v[36:39], v[44:47]
    v_cndmask_b32 v48, v48, v50, s[8:9]
    v_cndmask_b32 v49, v49, v51, s[8:9]
    v_cndmask_b32 v48, v48, v49, s[16:17]
    s_nop 1
    v_add_f32_dpp v48, v48, v48 quad_perm:[1,0,3,2] row_mask:0xf bank_mask:0xf
    v_cvt_pk_bf16_f32 v48, 0, v48
    v_mul_f32 v48, 0x3d93cd3a, v48
    v_cvt_pk_bf16_f32 v25, 0, v48
    v_mfma_f32_16x16x32_bf16 v[48:51], v[148:151], v[28:31], 0
    v_mfma_f32_16x16x32_bf16 v[48:51], v[152:155], v[32:35], v[48:51]
    v_mfma_f32_16x16x32_bf16 v[48:51], v[156:159], v[36:39], v[48:51]
    v_cndmask_b32 v44, v44, v46, s[8:9]
    v_cndmask_b32 v45, v45, v47, s[8:9]
    v_cndmask_b32 v44, v44, v45, s[16:17]
    s_nop 1
    v_add_f32_dpp v44, v44, v44 quad_perm:[1,0,3,2] row_mask:0xf bank_mask:0xf
    v_cvt_pk_bf16_f32 v44, 0, v44
    v_mul_f32 v44, 0x3d93cd3a, v44
    v_cvt_pk_bf16_f32 v26, 0, v44
    v_cndmask_b32 v48, v48, v50, s[8:9]
    v_cndmask_b32 v49, v49, v51, s[8:9]
    v_cndmask_b32 v48, v48, v49, s[16:17]
    s_nop 1
    v_add_f32_dpp v48, v48, v48 quad_perm:[1,0,3,2] row_mask:0xf bank_mask:0xf
    v_cvt_pk_bf16_f32 v48, 0, v48
    v_mul_f32 v48, 0x3d93cd3a, v48
    v_cvt_pk_bf16_f32 v27, 0, v48
    v_lshrrev_b32 v46, 3, v0
    s_lshl_b32 s16, s3, 5
    v_lshl_add_u32 v58, v46, 2, s16
    ds_write_b32 v58, v23 offset:52480
    v_max3_f32 v44, v20, v21, v22
    v_max_f32 v44, v44, v23
    v_mul_f32 v44, s67, v44
    v_max3_f32 v46, v24, v25, v26
    v_max_f32 v46, v46, v27
    v_mul_f32 v46, s67, v46
    v_fma_f32 v20, v20, s67, -v44
    v_fma_f32 v21, v21, s67, -v44
    v_fma_f32 v22, v22, s67, -v44
    v_fma_f32 v23, v23, s67, -v44
    v_fma_f32 v24, v24, s67, -v46
    v_fma_f32 v25, v25, s67, -v46
    v_fma_f32 v26, v26, s67, -v46
    v_fma_f32 v27, v27, s67, -v46
    v_exp_f32 v20, v20
    v_exp_f32 v21, v21
    v_exp_f32 v22, v22
    v_exp_f32 v23, v23
    v_exp_f32 v24, v24
    v_exp_f32 v25, v25
    v_exp_f32 v26, v26
    v_exp_f32 v27, v27
    v_and_b32 v48, 0x38, v0
    s_lshl_b32 s16, s3, 7
    v_lshl_add_u32 v48, v48, 1, s16
    v_add_f32 v45, v20, v21
    v_add_f32 v45, v45, v22
    v_add_f32 v45, v45, v23
    v_add_f32 v47, v24, v25
    v_add_f32 v47, v47, v26
    v_add_f32 v47, v47, v27
    ds_write_b128 v48, v[44:47] offset:49920
    s_waitcnt vmcnt(0)
    s_add_u32 s11, s10, 201719808
    buffer_load_dwordx4 v[172:175], v2, s[28:31], s11 offen offset:0 nt
    buffer_load_dwordx4 v[176:179], v2, s[28:31], s11 offen offset:128 nt
    buffer_load_dwordx4 v[180:183], v2, s[28:31], s11 offen offset:256 nt
    s_cmp_eq_u32 s3, 3
    s_cbranch_scc0 L_sk40
    s_lshl_b32 s35, s7, 7
    s_add_u32 s35, s35, 8192
    s_mov_b32 exec_hi, 0
    buffer_load_dword v42, v53, s[36:39], s35 offen sc1
    s_mov_b64 exec, -1
    s_add_u32 s58, s58, 1
L_sk40:
    s_cmp_lt_u32 s3, 4
    s_cbranch_scc0 L_sk41
    s_cmp_eq_u32 s12, 0
    s_cbranch_scc0 L_esf
    v_mov_b32 v156, 0
    v_mov_b32 v157, 0
    v_mov_b32 v158, 0
    v_mov_b32 v159, 0
    s_or_b32 s16, s69, s3
    s_cmp_eq_u32 s16, 0
    s_cbranch_scc0 L_sk42
    s_lshl_b32 s17, s68, 7
    v_lshl_add_u32 v47, v0, 1, s17
    s_mov_b64 exec, 0xffff
    buffer_load_ushort v156, v47, s[20:23], 0 offen offset:0
    buffer_load_ushort v157, v47, s[20:23], 0 offen offset:32
    buffer_load_ushort v158, v47, s[20:23], 0 offen offset:64
    buffer_load_ushort v159, v47, s[20:23], 0 offen offset:96
    s_mov_b64 exec, -1
    s_add_u32 s58, s58, 4
L_sk42:
    s_branch L_ese
L_esf:
    v_and_b32 v49, 7, v0
    v_bfe_u32 v50, v0, 4, 1
    v_lshl_add_u32 v49, v50, 3, v49
    s_lshl_b32 s17, s68, 5
    v_lshl_add_u32 v47, v49, 1, s17
    buffer_load_ushort v56, v47, s[48:51], 0 offen
    v_lshlrev_b32 v61, 4, v49
    s_add_u32 s58, s58, 1
L_ese:
L_sk41:
    s_waitcnt vmcnt(6)
    s_cmp_ge_u32 s58, 6
    s_cbranch_scc1 L_ld43
    s_waitcnt vmcnt(5)
    s_cmp_ge_u32 s58, 5
    s_cbranch_scc1 L_ld43
    s_waitcnt vmcnt(4)
    s_cmp_ge_u32 s58, 4
    s_cbranch_scc1 L_ld43
    s_waitcnt vmcnt(2)
    s_cmp_ge_u32 s58, 2
    s_cbranch_scc1 L_ld43
    s_waitcnt vmcnt(1)
    s_cmp_ge_u32 s58, 1
    s_cbranch_scc1 L_ld43
    s_waitcnt vmcnt(0)
L_ld43:
    s_mov_b32 s58, 0
    s_add_u32 s11, s10, 202113024
    buffer_load_dwordx4 v[184:187], v2, s[28:31], s11 offen offset:0 nt
    buffer_load_dwordx4 v[188:191], v2, s[28:31], s11 offen offset:128 nt
    buffer_load_dwordx4 v[192:195], v2, s[28:31], s11 offen offset:256 nt
    s_cmp_eq_u32 s3, 3
    s_cbranch_scc0 L_sk44
    s_waitcnt vmcnt(3)
    s_lshl_b32 s35, s7, 7
    s_add_u32 s35, s35, 8192
    s_lshl_b32 s11, s6, 2
    v_mov_b32 v47, s11
    v_mov_b32 v43, 0
    s_mov_b64 exec, 1
    buffer_store_dword v43, v47, s[36:39], s35 offen
    s_mov_b64 exec, -1
    s_add_u32 s58, s58, 1
    s_mov_b32 exec_hi, 0
    v_cmp_eq_u32 vcc, 0, v42
    s_bcnt1_i32_b64 s35, vcc
    s_mov_b64 exec, -1
    v_mov_b32 v42, s35
    ds_write_b32 v43, v42 offset:51056
L_sk44:
L_mlb_rd:
    ds_read_b128 v[48:51], v52 offset:49920
    s_waitcnt lgkmcnt(0)
    v_max3_u32 v8, v48, v49, v50
    v_max_u32 v8, v8, v51
    v_cmp_eq_u32 vcc, -1, v8
    s_cbranch_vccz L_mlb_ok
    s_cmp_eq_u32 s15, 0
    s_cbranch_scc1 L_mlb_ok
    s_sub_u32 s15, s15, 1
    s_sleep 2
    s_branch L_mlb_rd
L_mlb_ok:
    v_xor_b32 v58, 128, v58
    ds_read_b32 v58, v58 offset:52480
    v_mov_b32 v8, v48
    v_mov_b32 v10, v50
    s_nop 0
    v_max_f32_dpp v8, v8, v8 quad_perm:[1,0,3,2] row_mask:0xf bank_mask:0xf
    v_max_f32_dpp v10, v10, v10 quad_perm:[1,0,3,2] row_mask:0xf bank_mask:0xf
    s_nop 0
    v_max_f32_dpp v8, v8, v8 quad_perm:[2,3,0,1] row_mask:0xf bank_mask:0xf
    v_max_f32_dpp v10, v10, v10 quad_perm:[2,3,0,1] row_mask:0xf bank_mask:0xf
    s_nop 0
    v_max_f32_dpp v8, v8, v8 row_half_mirror row_mask:0xf bank_mask:0xf
    v_max_f32_dpp v10, v10, v10 row_half_mirror row_mask:0xf bank_mask:0xf
    s_nop 0
    v_max_f32_dpp v8, v8, v8 row_mirror row_mask:0xf bank_mask:0xf
    v_max_f32_dpp v10, v10, v10 row_mirror row_mask:0xf bank_mask:0xf
    s_nop 0
    v_max_f32_dpp v8, v8, v8 row_bcast:15 row_mask:0xa bank_mask:0xf
    v_max_f32_dpp v10, v10, v10 row_bcast:15 row_mask:0xa bank_mask:0xf
    s_nop 0
    v_max_f32_dpp v8, v8, v8 row_bcast:31 row_mask:0xc bank_mask:0xf
    v_max_f32_dpp v10, v10, v10 row_bcast:31 row_mask:0xc bank_mask:0xf
    v_readlane_b32 s14, v8, 63
    v_readlane_b32 s32, v10, 63
    s_waitcnt lgkmcnt(0)
    v_mov_b32 v45, s14
    v_fma_f32 v58, v58, s67, -v45
    v_exp_f32 v58, v58
    s_nop 0
    v_cvt_pk_bf16_f32 v58, v58, v58
    v_subrev_f32 v44, s14, v44
    v_subrev_f32 v46, s32, v46
    v_exp_f32 v44, v44
    v_exp_f32 v46, v46
    s_cmp_eq_u32 s3, 6
    s_cbranch_scc0 L_sk45
    v_subrev_f32 v48, s14, v48
    v_subrev_f32 v50, s32, v50
    v_exp_f32 v48, v48
    v_exp_f32 v50, v50
    v_mul_f32 v9, v48, v49
    v_mul_f32 v11, v50, v51
    s_nop 0
    v_add_f32_dpp v9, v9, v9 quad_perm:[1,0,3,2] row_mask:0xf bank_mask:0xf
    v_add_f32_dpp v11, v11, v11 quad_perm:[1,0,3,2] row_mask:0xf bank_mask:0xf
    s_nop 0
    v_add_f32_dpp v9, v9, v9 quad_perm:[2,3,0,1] row_mask:0xf bank_mask:0xf
    v_add_f32_dpp v11, v11, v11 quad_perm:[2,3,0,1] row_mask:0xf bank_mask:0xf
    s_nop 0
    v_add_f32_dpp v9, v9, v9 row_half_mirror row_mask:0xf bank_mask:0xf
    v_add_f32_dpp v11, v11, v11 row_half_mirror row_mask:0xf bank_mask:0xf
    s_nop 0
    v_add_f32_dpp v9, v9, v9 row_mirror row_mask:0xf bank_mask:0xf
    v_add_f32_dpp v11, v11, v11 row_mirror row_mask:0xf bank_mask:0xf
    s_nop 0
    v_add_f32_dpp v9, v9, v9 row_bcast:15 row_mask:0xa bank_mask:0xf
    v_add_f32_dpp v11, v11, v11 row_bcast:15 row_mask:0xa bank_mask:0xf
    s_nop 0
    v_add_f32_dpp v9, v9, v9 row_bcast:31 row_mask:0xc bank_mask:0xf
    v_add_f32_dpp v11, v11, v11 row_bcast:31 row_mask:0xc bank_mask:0xf
    s_lshl_b32 s16, s4, 8
    s_lshl4_add_u32 s16, s5, s16
    s_add_u32 s16, s16, 4096
    v_mov_b32 v47, s16
    s_mov_b32 exec_lo, 0x0
    s_mov_b32 exec_hi, 0x80000000
    buffer_store_dwordx4 v[8:11], v47, s[36:39], 0 offen sc1
    s_mov_b64 exec, -1
    s_add_u32 s58, s58, 1
L_sk45:
    v_mul_f32 v24, v24, v46
    v_cvt_pk_bf16_f32 v24, v24, v24
    v_and_b32 v64, v24, v4
    v_and_b32 v65, v24, v5
    v_and_b32 v66, v24, v6
    v_and_b32 v67, v24, v7
    v_mul_f32 v25, v25, v46
    v_cvt_pk_bf16_f32 v25, v25, v25
    v_and_b32 v68, v25, v4
    v_and_b32 v69, v25, v5
    v_and_b32 v70, v25, v6
    v_and_b32 v71, v25, v7
    v_mul_f32 v26, v26, v46
    v_cvt_pk_bf16_f32 v26, v26, v26
    v_and_b32 v72, v26, v4
    v_and_b32 v73, v26, v5
    v_and_b32 v74, v26, v6
    v_and_b32 v75, v26, v7
    v_mul_f32 v27, v27, v46
    v_cvt_pk_bf16_f32 v27, v27, v27
    v_and_b32 v76, v27, v4
    v_and_b32 v77, v27, v5
    v_and_b32 v78, v27, v6
    v_and_b32 v79, v27, v7
    v_mul_f32 v20, v20, v44
    v_cvt_pk_bf16_f32 v20, v20, v20
    v_and_b32 v80, v20, v4
    v_and_b32 v81, v20, v5
    v_and_b32 v82, v20, v6
    v_and_b32 v83, v20, v7
    v_mul_f32 v21, v21, v44
    v_cvt_pk_bf16_f32 v21, v21, v21
    v_and_b32 v84, v21, v4
    v_and_b32 v85, v21, v5
    v_and_b32 v86, v21, v6
    v_and_b32 v87, v21, v7
    v_mul_f32 v22, v22, v44
    v_cvt_pk_bf16_f32 v22, v22, v22
    v_and_b32 v88, v22, v4
    v_and_b32 v89, v22, v5
    v_and_b32 v90, v22, v6
    v_and_b32 v91, v22, v7
    v_mul_f32 v23, v23, v44
    v_cvt_pk_bf16_f32 v23, v23, v23
    v_and_b32 v92, v23, v4
    v_and_b32 v93, v23, v5
    v_and_b32 v94, v23, v6
    v_and_b32 v95, v23, v7
    v_mfma_f32_16x16x32_bf16 v[28:31], v[64:67], v[160:163], 0
    v_mfma_f32_16x16x32_bf16 v[32:35], v[64:67], v[164:167], 0
    v_mfma_f32_16x16x32_bf16 v[36:39], v[64:67], v[168:171], 0
    v_mfma_f32_16x16x32_bf16 v[28:31], v[68:71], v[172:175], v[28:31]
    v_mfma_f32_16x16x32_bf16 v[32:35], v[68:71], v[176:179], v[32:35]
    v_mfma_f32_16x16x32_bf16 v[36:39], v[68:71], v[180:183], v[36:39]
    s_waitcnt vmcnt(2)
    s_cmp_ge_u32 s58, 2
    s_cbranch_scc1 L_ld46
    s_waitcnt vmcnt(1)
    s_cmp_ge_u32 s58, 1
    s_cbranch_scc1 L_ld46
    s_waitcnt vmcnt(0)
L_ld46:
    s_mov_b32 s58, 0
    s_add_u32 s11, s10, 202506240
    buffer_load_dwordx4 v[196:199], v2, s[28:31], s11 offen offset:0 nt
    buffer_load_dwordx4 v[200:203], v2, s[28:31], s11 offen offset:128 nt
    buffer_load_dwordx4 v[204:207], v2, s[28:31], s11 offen offset:256 nt
    v_mov_b32 v47, 0
    ds_read_b32 v47, v47 offset:51056
    s_lshl_b32 s35, s3, 2
    s_lshr_b32 s35, 0xcdcceedd, s35
    s_and_b32 s35, s35, 15
    s_lshl_b32 s11, 1, s35
    s_waitcnt lgkmcnt(0)
    v_readfirstlane_b32 s35, v47
    s_cmp_ge_i32 s35, 3
    s_cselect_b32 s11, s11, 0
    s_or_b32 s34, s34, s11
    v_mfma_f32_16x16x32_bf16 v[28:31], v[72:75], v[184:187], v[28:31]
    v_mfma_f32_16x16x32_bf16 v[32:35], v[72:75], v[188:191], v[32:35]
    v_mfma_f32_16x16x32_bf16 v[36:39], v[72:75], v[192:195], v[36:39]
    s_cmp_lt_u32 s3, 4
    s_cbranch_scc0 L_sk47
    s_cmp_eq_u32 s12, 0
    s_cbranch_scc0 L_pf1
    v_bfe_u32 v47, v0, 4, 1
    v_and_b32 v48, 3, v0
    v_lshrrev_b32 v50, 4, v0
    v_and_b32 v49, 15, v0
    v_mul_u32_u24 v54, 384, v49
    v_lshl_add_u32 v54, v50, 4, v54
    s_lshr_b32 s17, s3, 1
    s_mul_i32 s17, s17, 98304
    s_and_b32 s16, s3, 1
    s_mul_i32 s16, s16, 192
    s_add_u32 s16, s16, s17
    s_mul_i32 s17, s69, 6144
    s_add_u32 s16, s16, s17
    s_add_u32 s16, s16, 819200
    v_add_u32 v54, s16, v54
    v_lshrrev_b32 v51, 2, v0
    v_mul_u32_u24 v24, 384, v51
    v_sub_u32 v51, 0, v50
    v_xor_b32 v51, v51, v0
    v_and_b32 v51, 3, v51
    v_lshl_add_u32 v24, v51, 4, v24
    v_add_u32 v24, s16, v24
    v_lshrrev_b32 v51, 2, v49
    v_sub_u32 v51, 0, v51
    v_xor_b32 v51, v51, v50
    v_and_b32 v51, 3, v51
    v_lshl_add_u32 v25, v49, 2, v51
    s_mul_i32 s17, s3, 3072
    s_add_u32 s17, s17, 52736
    v_lshl_add_u32 v25, v25, 4, s17
    v_bfe_u32 v51, v0, 2, 2
    v_lshl_add_u32 v50, v50, 3, v51
    v_lshlrev_b32 v50, 7, v50
    v_lshl_add_u32 v50, v48, 3, v50
    v_lshrrev_b32 v51, 1, v51
    v_lshl_add_u32 v51, v47, 1, v51
    v_lshl_add_u32 v50, v51, 5, v50
    v_add_u32 v40, s19, v50
    v_xor_b32 v41, 32, v40
    v_xor_b32 v42, 64, v40
    v_xor_b32 v43, 96, v40
    ds_read_b64_tr_b16 v[96:97], v40 offset:0
    ds_read_b64_tr_b16 v[98:99], v40 offset:512
    ds_read_b64_tr_b16 v[100:101], v40 offset:4096
    ds_read_b64_tr_b16 v[102:103], v40 offset:4608
    ds_read_b64_tr_b16 v[108:109], v41 offset:0
    ds_read_b64_tr_b16 v[110:111], v41 offset:512
    ds_read_b64_tr_b16 v[112:113], v41 offset:4096
    ds_read_b64_tr_b16 v[114:115], v41 offset:4608
    ds_read_b64_tr_b16 v[120:121], v42 offset:0
    ds_read_b64_tr_b16 v[122:123], v42 offset:512
    ds_read_b64_tr_b16 v[124:125], v42 offset:4096
    ds_read_b64_tr_b16 v[126:127], v42 offset:4608
    ds_read_b64_tr_b16 v[132:133], v43 offset:0
    ds_read_b64_tr_b16 v[134:135], v43 offset:512
    ds_read_b64_tr_b16 v[136:137], v43 offset:4096
    ds_read_b64_tr_b16 v[138:139], v43 offset:4608
    v_and_b32 v47, 31, v0
    v_lshlrev_b32 v61, 5, v47
    v_and_b32 v48, 1, v0
    v_mul_u32_u24 v48, 12, v48
    v_sub_u32 v55, v52, v48
    s_lshl_b32 s17, s3, 3
    v_add_u32 v55, s17, v55
    s_lshr_b32 s18, s69, 2
    s_mul_i32 s18, s18, 16384
    s_and_b32 s17, s69, 3
    s_mul_i32 s17, s17, 1280
    s_add_u32 s17, s17, s18
    s_lshl_b32 s18, s3, 16
    s_add_u32 s17, s17, s18
    s_lshl_b32 s18, s68, 7
    s_add_u32 s17, s17, s18
    s_add_u32 s17, s17, 32768
    v_lshrrev_b32 v48, 5, v0
    v_lshlrev_b32 v48, 13, v48
    v_lshl_add_u32 v57, v47, 2, s17
    v_add_u32 v57, v57, v48
    v_lshlrev_b32 v8, 16, v156
    v_mov_b32 v9, 0
    v_mov_b32 v10, 0
    v_mov_b32 v11, 0
    v_lshlrev_b32 v12, 16, v157
    v_mov_b32 v13, 0
    v_mov_b32 v14, 0
    v_mov_b32 v15, 0
    v_lshlrev_b32 v16, 16, v158
    v_mov_b32 v17, 0
    v_mov_b32 v18, 0
    v_mov_b32 v19, 0
    v_lshlrev_b32 v20, 16, v159
    v_mov_b32 v21, 0
    v_mov_b32 v22, 0
    v_mov_b32 v23, 0
    s_branch L_pf1e
L_pf1:
    v_and_b32 v47, 15, v0
    v_lshrrev_b32 v48, 4, v0
    v_and_b32 v50, 1, v48
    v_lshrrev_b32 v51, 5, v0
    s_mul_i32 s16, s3, 320
    v_bfe_u32 v49, v0, 2, 2
    v_and_b32 v45, 3, v0
    v_lshl_add_u32 v40, v48, 3, v49
    v_lshlrev_b32 v40, 5, v40
    v_lshl_add_u32 v40, v45, 3, v40
    v_add_u32 v40, s19, v40
    v_lshl_add_u32 v41, v50, 3, v49
    v_mul_u32_u24 v41, 320, v41
    v_lshl_add_u32 v45, v45, 1, v51
    v_mad_u32_u24 v41, v45, 40, v41
    v_add_u32 v41, s19, v41
    v_mul_u32_u24 v45, 13, v0
    v_lshrrev_b32 v45, 8, v45
    v_mul_u32_u24 v45, 960, v45
    s_mul_i32 s17, s68, 20480
    s_add_u32 s17, s17, s16
    v_add3_u32 v62, v45, v52, s17
    v_mov_b32 v136, 0x3f803f80
    v_mov_b32 v137, 0x3f803f80
    v_mov_b32 v138, 0x3f803f80
    v_mov_b32 v139, 0x3f803f80
    v_cmp_eq_u32 s[8:9], 0, v47
    v_lshl_add_u32 v46, v48, 4, s16
    v_lshrrev_b32 v45, 2, v47
    v_mul_u32_u24 v45, 16384, v45
    v_and_b32 v54, 3, v47
    v_mul_u32_u24 v54, 1280, v54
    v_add_u32 v54, v54, v45
    s_and_b32 s17, s7, 3
    s_lshr_b32 s17, s17, 0
    s_lshl_b32 s17, s17, 16
    s_add_u32 s17, s17, 32768
    v_add3_u32 v54, v54, v46, s17
    v_lshrrev_b32 v45, 2, v0
    v_lshrrev_b32 v9, 2, v45
    v_mul_u32_u24 v9, 16384, v9
    v_and_b32 v8, 3, v45
    v_mul_u32_u24 v8, 1280, v8
    v_add_u32 v8, v8, v9
    v_sub_u32 v45, 0, v48
    v_xor_b32 v45, v45, v0
    v_and_b32 v45, 3, v45
    v_lshl_add_u32 v8, v45, 4, v8
    s_add_u32 s17, s17, s16
    v_add_u32 v8, s17, v8
    v_sub_u32 v45, 0, v49
    v_xor_b32 v45, v45, v48
    v_and_b32 v45, 3, v45
    v_lshl_add_u32 v45, v47, 2, v45
    v_lshl_add_u32 v9, v45, 4, s19
    v_lshl_add_u32 v45, v51, 4, v47
    s_lshl_b32 s17, s3, 2
    v_lshl_add_u32 v55, v45, 4, s17
    v_lshlrev_b32 v46, 2, v47
    s_lshl1_add_u32 s17, s17, 256
    v_add_u32 v46, s17, v46
    v_and_b32 v45, 0x2e, v0
    v_cmp_eq_u32 vcc, 32, v45
    s_nop 1
    v_cndmask_b32 v55, v55, v46, vcc
    v_bfe_u32 v45, v0, 3, 1
    v_and_b32 v46, 7, v0
    v_lshrrev_b32 v47, 3, v0
    v_mad_u32_u24 v47, v47, 5, v46
    v_lshrrev_b32 v10, 3, v47
    s_mul_i32 s17, s3, 5
    v_add_u32 v10, s17, v10
    v_lshrrev_b32 v19, 2, v10
    v_lshlrev_b32 v19, 16, v19
    v_and_b32 v11, 1, v10
    v_lshl_add_u32 v19, v11, 15, v19
    v_and_b32 v11, 2, v10
    v_lshl_add_u32 v19, v11, 12, v19
    v_and_b32 v47, 7, v47
    v_lshl_add_u32 v19, v47, 4, v19
    s_lshr_b32 s18, s68, 6
    s_mul_i32 s18, s18, 16384
    s_and_b32 s17, s68, 63
    s_mul_i32 s17, s17, 128
    s_add_u32 s17, s17, s18
    s_add_u32 s17, s17, 294912
    v_add_u32 v19, s17, v19
    v_cmp_eq_u32 vcc, 0, v46
    s_nop 1
    v_cndmask_b32 v140, 0, -1, vcc
    v_cmp_eq_u32 vcc, 1, v46
    s_nop 1
    v_cndmask_b32 v141, 0, -1, vcc
    v_cmp_eq_u32 vcc, 2, v46
    s_nop 1
    v_cndmask_b32 v142, 0, -1, vcc
    v_cmp_eq_u32 vcc, 3, v46
    s_nop 1
    v_cndmask_b32 v143, 0, -1, vcc
    v_cmp_eq_u32 vcc, 4, v46
    s_nop 1
    v_cndmask_b32 v144, 0, -1, vcc
    v_cmp_eq_u32 vcc, v45, v51
    v_lshlrev_b32 v56, 16, v56
    v_mov_b32 v17, 0
    v_mov_b32 v45, 0xff800000
    v_cndmask_b32 v56, v45, v56, vcc
L_pf1e:
L_sk47:
    s_bitcmp0_b32 s34, 12
    s_cbranch_scc0 L_sk48
    s_waitcnt vmcnt(0)
L_sk48:
    s_mov_b32 s58, 0
    s_add_u32 s11, s10, 0
    buffer_load_dwordx4 v[208:211], v2, s[28:31], s11 offen offset:0 nt
    buffer_load_dwordx4 v[212:215], v2, s[28:31], s11 offen offset:128 nt
    buffer_load_dwordx4 v[216:219], v2, s[28:31], s11 offen offset:256 nt
    s_bitcmp1_b32 s34, 12
    s_cbranch_scc0 L_sk50
    s_waitcnt vmcnt(3)
L_sk50:
    v_mfma_f32_16x16x32_bf16 v[28:31], v[76:79], v[196:199], v[28:31]
    v_mfma_f32_16x16x32_bf16 v[32:35], v[76:79], v[200:203], v[32:35]
    v_mfma_f32_16x16x32_bf16 v[36:39], v[76:79], v[204:207], v[36:39]
    s_lshl_b32 s16, s3, 2
    v_mov_b32 v47, s16
    s_mov_b32 exec_lo, 0xff00ff
    s_mov_b32 exec_hi, 0xff00ff00
    s_nop 1
    ds_write_b128 v60, v[28:31] offset:13568
    ds_write_b128 v60, v[32:35] offset:13824
    ds_write_b128 v60, v[36:39] offset:14080
    s_mov_b64 exec, -1
    s_waitcnt lgkmcnt(0)
    ds_write_b32 v47, v47 offset:51024
    v_and_b32 v156, v58, v4
    v_and_b32 v157, v58, v5
    v_and_b32 v158, v58, v6
    v_and_b32 v159, v58, v7
    s_bitcmp0_b32 s34, 13
    s_cbranch_scc0 L_sk51
    s_waitcnt vmcnt(0)
L_sk51:
    s_mov_b32 s58, 0
    s_add_u32 s11, s10, 393216
    buffer_load_dwordx4 v[220:223], v2, s[28:31], s11 offen offset:0 nt
    buffer_load_dwordx4 v[224:227], v2, s[28:31], s11 offen offset:128 nt
    buffer_load_dwordx4 v[228:231], v2, s[28:31], s11 offen offset:256 nt
    s_bitcmp1_b32 s34, 13
    s_cbranch_scc0 L_sk53
    s_waitcnt vmcnt(3)
L_sk53:
    s_cmp_eq_u32 s3, 4
    s_cbranch_scc0 L_sk54
    v_mov_b32 v63, 0
    buffer_load_dword v7, v63, s[40:43], 0 offen offset:128 sc1
    s_add_u32 s58, s58, 1
L_sk54:
    s_cmp_eq_u32 s3, 4
    s_cbranch_scc0 L_sk55
    v_bfe_u32 v3, v0, 4, 1
    v_and_b32 v49, 15, v0
    v_lshl_add_u32 v3, v49, 1, v3
    s_lshl_b32 s16, s4, 8
    s_add_u32 s16, s16, 4096
    v_lshl_add_u32 v3, v3, 3, s16
    buffer_load_dwordx2 v[4:5], v3, s[36:39], 0 offen sc1
    s_add_u32 s58, s58, 1
L_sk55:
    v_mfma_f32_16x16x32_bf16 v[28:31], v[80:83], v[208:211], 0
    v_mfma_f32_16x16x32_bf16 v[32:35], v[80:83], v[212:215], 0
    v_mfma_f32_16x16x32_bf16 v[36:39], v[80:83], v[216:219], 0
    s_bitcmp0_b32 s34, 14
    s_cbranch_scc0 L_sk56
    s_waitcnt vmcnt(2)
    s_cmp_ge_u32 s58, 2
    s_cbranch_scc1 L_ld57
    s_waitcnt vmcnt(1)
    s_cmp_ge_u32 s58, 1
    s_cbranch_scc1 L_ld57
    s_waitcnt vmcnt(0)
L_ld57:
    s_mov_b32 s58, 0
L_sk56:
    s_mov_b32 s58, 0
    s_add_u32 s11, s10, 786432
    buffer_load_dwordx4 v[232:235], v2, s[28:31], s11 offen offset:0 nt
    buffer_load_dwordx4 v[236:239], v2, s[28:31], s11 offen offset:128 nt
    buffer_load_dwordx4 v[240:243], v2, s[28:31], s11 offen offset:256 nt
    s_bitcmp1_b32 s34, 14
    s_cbranch_scc0 L_sk58
    s_waitcnt vmcnt(3)
L_sk58:
    s_cmp_eq_u32 s3, 4
    s_cbranch_scc0 L_sk59
    s_waitcnt vmcnt(3)
L_sk59:
    s_cmp_eq_u32 s3, 4
    s_cbranch_scc0 L_sk60
    s_branch L_go2_chk
L_go2_again:
    s_cmp_lg_u32 s15, 0
    s_cbranch_scc0 L_go2_ok
    s_sub_u32 s15, s15, 1
    s_sleep 4
    s_mov_b64 exec, vcc
    buffer_load_dword v7, v63, s[40:43], 0 offen offset:128 sc1
    s_mov_b64 exec, -1
    s_waitcnt vmcnt(0)
L_go2_chk:
    v_cmp_eq_u32 vcc, 0, v7
    s_cbranch_vccnz L_go2_again
L_go2_ok:
L_sk60:
    v_mfma_f32_16x16x32_bf16 v[28:31], v[84:87], v[220:223], v[28:31]
    v_mfma_f32_16x16x32_bf16 v[32:35], v[84:87], v[224:227], v[32:35]
    v_mfma_f32_16x16x32_bf16 v[36:39], v[84:87], v[228:231], v[36:39]
    s_cmp_eq_u32 s3, 4
    s_cbranch_scc0 L_sk61
    s_branch L_mg_chk
L_mg_again:
    s_cmp_lg_u32 s15, 0
    s_cbranch_scc0 L_mg_ok
    s_sub_u32 s15, s15, 1
    s_sleep 2
    s_mov_b64 exec, vcc
    buffer_load_dwordx2 v[4:5], v3, s[36:39], 0 offen sc1
    s_mov_b64 exec, -1
    s_waitcnt vmcnt(0)
L_mg_chk:
    v_max_u32 v49, v4, v5
    v_cmp_eq_u32 vcc, -1, v49
    s_cbranch_vccnz L_mg_again
L_mg_ok:
    v_mov_b32 v6, v4
    v_mov_b32 v49, s14
    v_mov_b32 v50, s32
    s_nop 1
    v_mov_b32_dpp v49, v50 quad_perm:[0,1,2,3] row_mask:0xa bank_mask:0xf
    v_max_f32_dpp v6, v6, v6 quad_perm:[1,0,3,2] row_mask:0xf bank_mask:0xf
    s_nop 1
    v_max_f32_dpp v6, v6, v6 quad_perm:[2,3,0,1] row_mask:0xf bank_mask:0xf
    s_nop 1
    v_max_f32_dpp v6, v6, v6 row_half_mirror row_mask:0xf bank_mask:0xf
    s_nop 1
    v_max_f32_dpp v6, v6, v6 row_mirror row_mask:0xf bank_mask:0xf
    v_sub_f32 v4, v4, v6
    v_sub_f32 v6, v49, v6
    v_exp_f32 v4, v4
    v_exp_f32 v6, v6
    v_mul_f32 v4, v4, v5
    s_nop 1
    v_add_f32_dpp v4, v4, v4 quad_perm:[1,0,3,2] row_mask:0xf bank_mask:0xf
    s_nop 1
    v_add_f32_dpp v4, v4, v4 quad_perm:[2,3,0,1] row_mask:0xf bank_mask:0xf
    s_nop 1
    v_add_f32_dpp v4, v4, v4 row_half_mirror row_mask:0xf bank_mask:0xf
    s_nop 1
    v_add_f32_dpp v4, v4, v4 row_mirror row_mask:0xf bank_mask:0xf
    v_rcp_f32 v4, v4
    v_and_b32 v5, 16, v0
    v_lshrrev_b32 v5, 1, v5
    v_mul_f32 v6, v4, v6
    ds_write_b64 v5, v[6:7] offset:51008
L_sk61:
    s_cmp_lt_u32 s3, 4
    s_cbranch_scc1 L_lowwaves
    s_setprio 2
    s_lshl_b32 s17, s3, 2
    v_mov_b32 v4, s17
    ds_write_b32 v4, v4 offset:50976
    s_cmp_eq_u32 s3, 7
    s_cbranch_scc0 L_sk62
    s_waitcnt vmcnt(0)
    s_branch L_redret
L_sk62:
    s_sub_u32 s16, s3, 4
    s_lshl_b32 s16, s16, 7
    s_add_u32 s16, s16, s13
    s_add_u32 s18, s16, 0
    s_add_u32 s16, s16, 98304
    v_lshlrev_b32 v47, 1, v0
    v_min_u32 v46, 44, v53
L_first_rd:
    ds_read_b32 v45, v46 offset:51008
    s_waitcnt lgkmcnt(0)
    v_cmp_eq_u32 vcc, -1, v45
    s_cbranch_vccz L_first_ok
    s_cmp_eq_u32 s15, 0
    s_cbranch_scc1 L_first_ok
    s_sub_u32 s15, s15, 1
    s_sleep 2
    s_branch L_first_rd
L_first_ok:
    v_mov_b32 v46, 8
    v_add_u32 v48, 13568, v61
    s_cmp_eq_u32 s2, s2
    s_branch L_red
.p2align 6
.fill 4, 4, 0xbf800000
L_redret:
    s_mov_b64 exec, -1
    s_mov_b32 s16, s18
    v_mov_b32 v46, 0
    v_mov_b32 v48, v61
    s_waitcnt vmcnt(3)
    v_mfma_f32_16x16x32_bf16 v[28:31], v[88:91], v[232:235], v[28:31]
    s_waitcnt vmcnt(2)
    v_mfma_f32_16x16x32_bf16 v[32:35], v[88:91], v[236:239], v[32:35]
    s_waitcnt vmcnt(1)
    v_mfma_f32_16x16x32_bf16 v[36:39], v[88:91], v[240:243], v[36:39]
    s_mov_b32 exec_lo, 0xff00ff
    s_mov_b32 exec_hi, 0xff00ff00
    s_nop 1
    ds_write_b128 v60, v[28:31] offset:0
    s_nop 0
    ds_write_b128 v60, v[32:35] offset:256
    s_nop 0
    ds_write_b128 v60, v[36:39] offset:512
    s_mov_b64 exec, -1
    s_waitcnt lgkmcnt(0)
    s_barrier
    s_cmp_eq_u32 s3, 7
    s_cbranch_scc1 L_bar2
L_red:
    ds_read_b128 v[96:99], v48 offset:0
    ds_read_b128 v[100:103], v48 offset:3328
    ds_read_b128 v[104:107], v48 offset:6656
    ds_read_b128 v[108:111], v48 offset:9984
    ds_read_b64 v[44:45], v46 offset:51008
    s_waitcnt lgkmcnt(3)
    v_pk_add_f32 v[96:97], v[96:97], v[100:101]
    v_pk_add_f32 v[98:99], v[98:99], v[102:103]
    s_waitcnt lgkmcnt(0)
    v_pk_add_f32 v[104:105], v[104:105], v[108:109]
    v_pk_add_f32 v[106:107], v[106:107], v[110:111]
    v_pk_add_f32 v[96:97], v[96:97], v[104:105]
    v_pk_add_f32 v[98:99], v[98:99], v[106:107]
    v_cmp_lt_i32 vcc, 0, v45
    v_add_f32_dpp v96, v96, v96 quad_perm:[1,0,3,2] row_mask:0xf bank_mask:0xf
    v_add_f32_dpp v97, v97, v97 quad_perm:[1,0,3,2] row_mask:0xf bank_mask:0xf
    v_add_f32_dpp v98, v98, v98 quad_perm:[1,0,3,2] row_mask:0xf bank_mask:0xf
    v_add_f32_dpp v99, v99, v99 quad_perm:[1,0,3,2] row_mask:0xf bank_mask:0xf
    v_add_f32_dpp v96, v96, v96 quad_perm:[2,3,0,1] row_mask:0xf bank_mask:0xf
    v_add_f32_dpp v97, v97, v97 quad_perm:[2,3,0,1] row_mask:0xf bank_mask:0xf
    v_add_f32_dpp v98, v98, v98 quad_perm:[2,3,0,1] row_mask:0xf bank_mask:0xf
    v_add_f32_dpp v99, v99, v99 quad_perm:[2,3,0,1] row_mask:0xf bank_mask:0xf
    v_pk_mul_f32 v[96:97], v[96:97], v[44:45] op_sel_hi:[1,0]
    v_pk_mul_f32 v[98:99], v[98:99], v[44:45] op_sel_hi:[1,0]
    v_cvt_pk_bf16_f32 v96, v96, v97
    v_cvt_pk_bf16_f32 v97, v98, v99
    s_mov_b32 exec_lo, 0x11111111
    s_mov_b32 exec_hi, 0x11111111
    s_cbranch_vccz L_pubfar
    buffer_store_dwordx2 v[96:97], v47, s[36:39], s16 offen
L_pubdone:
    s_cbranch_scc1 L_redret
L_bar2:
    s_barrier
L_done:
    s_endpgm
L_pubfar:
    buffer_store_dwordx2 v[96:97], v47, s[36:39], s16 offen sc1
    s_branch L_pubdone
L_lowwaves:
    s_waitcnt vmcnt(0)
    s_add_u32 s11, s10, 1179648
    buffer_load_dwordx4 v[244:247], v2, s[28:31], s11 offen offset:0 nt
    buffer_load_dwordx4 v[248:251], v2, s[28:31], s11 offen offset:128 nt
    buffer_load_dwordx4 v[252:255], v2, s[28:31], s11 offen offset:256 nt
    s_add_u32 s11, s11, 98304
    buffer_load_dwordx4 v[220:223], v2, s[28:31], s11 offen offset:0 nt
    buffer_load_dwordx4 v[224:227], v2, s[28:31], s11 offen offset:128 nt
    buffer_load_dwordx4 v[228:231], v2, s[28:31], s11 offen offset:256 nt
    s_lshl_b32 s17, s3, 2
    v_mov_b32 v4, s17
    ds_write_b32 v4, v4 offset:50976
    s_cmp_eq_u32 s12, 1
    s_cbranch_scc1 L_ffn
    s_cmp_eq_u32 s2, s2
    s_branch L_wo_body
L_wo_ret:
    s_mul_i32 s18, s3, 3072
    s_add_u32 s18, s18, 52736
    v_and_b32 v4, 28, v53
L_s7w_rd:
    ds_read_b32 v5, v4 offset:50976
    s_waitcnt lgkmcnt(0)
    v_cmp_eq_u32 vcc, -1, v5
    s_cbranch_vccz L_s7w_ok
    s_cmp_eq_u32 s15, 0
    s_cbranch_scc1 L_s7w_ok
    s_sub_u32 s15, s15, 1
    s_sleep 2
    s_branch L_s7w_rd
L_s7w_ok:
    s_add_u32 m0, s19, 8192
    s_mov_b32 s11, 81920
    buffer_load_dwordx4 v59, s[44:47], s11 offen nt lds
    s_add_u32 m0, s19, 9216
    s_mov_b32 s11, 92160
    buffer_load_dwordx4 v62, s[44:47], s11 offen nt lds
    s_add_u32 m0, s19, 10240
    s_mov_b32 s11, 102400
    buffer_load_dwordx4 v59, s[44:47], s11 offen nt lds
    s_add_u32 m0, s19, 11264
    s_mov_b32 s11, 112640
    buffer_load_dwordx4 v62, s[44:47], s11 offen nt lds
    v_mfma_f32_16x16x32_bf16 v[28:31], v[88:91], v[232:235], v[28:31]
    v_mfma_f32_16x16x32_bf16 v[32:35], v[88:91], v[236:239], v[32:35]
    v_mfma_f32_16x16x32_bf16 v[36:39], v[88:91], v[240:243], v[36:39]
    s_waitcnt vmcnt(9)
    v_mfma_f32_16x16x32_bf16 v[28:31], v[92:95], v[244:247], v[28:31]
    s_waitcnt vmcnt(8)
    v_mfma_f32_16x16x32_bf16 v[32:35], v[92:95], v[248:251], v[32:35]
    s_waitcnt vmcnt(7)
    v_mfma_f32_16x16x32_bf16 v[36:39], v[92:95], v[252:255], v[36:39]
    s_waitcnt vmcnt(6)
    v_mfma_f32_16x16x32_bf16 v[28:31], v[156:159], v[220:223], v[28:31]
    s_waitcnt vmcnt(5)
    v_mfma_f32_16x16x32_bf16 v[32:35], v[156:159], v[224:227], v[32:35]
    s_waitcnt vmcnt(4)
    v_mfma_f32_16x16x32_bf16 v[36:39], v[156:159], v[228:231], v[36:39]
    s_mov_b32 exec_lo, 0xff00ff
    s_mov_b32 exec_hi, 0xff00ff00
    s_nop 1
    ds_write_b128 v60, v[28:31] offset:0
    s_nop 0
    ds_write_b128 v60, v[32:35] offset:256
    s_nop 0
    ds_write_b128 v60, v[36:39] offset:512
    s_mov_b64 exec, -1
    s_waitcnt lgkmcnt(0)
    s_barrier
    s_barrier
    s_add_u32 m0, s18, 0
    s_nop 0
    buffer_load_dwordx4 v24, s[36:39], 0 offen offset:0 sc1 lds
    s_add_u32 m0, s18, 960
    s_nop 0
    buffer_load_dwordx4 v24, s[36:39], 0 offen offset:64 sc1 lds
    s_add_u32 m0, s18, 1920
    s_nop 0
    buffer_load_dwordx4 v24, s[36:39], 0 offen offset:128 sc1 lds
    s_waitcnt vmcnt(0) lgkmcnt(0)
    ds_read_b128 v[144:147], v25 offset:0
    ds_read_b128 v[148:151], v25 offset:1024
    ds_read_b128 v[152:155], v25 offset:2048
    ds_read_b64_tr_b16 v[104:105], v40 offset:8192
    ds_read_b64_tr_b16 v[106:107], v40 offset:8704
    ds_read_b64_tr_b16 v[116:117], v41 offset:8192
    ds_read_b64_tr_b16 v[118:119], v41 offset:8704
    ds_read_b64_tr_b16 v[128:129], v42 offset:8192
    ds_read_b64_tr_b16 v[130:131], v42 offset:8704
    ds_read_b64_tr_b16 v[140:141], v43 offset:8192
    ds_read_b64_tr_b16 v[142:143], v43 offset:8704
    s_branch L_op_wait
L_op_bulk:
    s_add_u32 m0, s18, 0
    s_nop 0
    buffer_load_dwordx4 v24, s[36:39], 0 offen offset:0 sc1 lds
    s_add_u32 m0, s18, 960
    s_nop 0
    buffer_load_dwordx4 v24, s[36:39], 0 offen offset:64 sc1 lds
    s_add_u32 m0, s18, 1920
    s_nop 0
    buffer_load_dwordx4 v24, s[36:39], 0 offen offset:128 sc1 lds
    s_waitcnt vmcnt(0) lgkmcnt(0)
    ds_read_b128 v[144:147], v25 offset:0
    ds_read_b128 v[148:151], v25 offset:1024
    ds_read_b128 v[152:155], v25 offset:2048
    s_waitcnt lgkmcnt(0)
    s_branch L_op_wait
.p2align 6
.fill 7, 4, 0xbf800000
L_op_again:
    s_cmp_lg_u32 s15, 0
    s_cbranch_scc0 L_op_ok
    s_sub_u32 s15, s15, 1
    s_bcnt1_i32_b64 s11, vcc
    s_cmp_gt_u32 s11, 24
    s_cbranch_scc1 L_op_bulk
    s_mov_b64 exec, vcc
    buffer_load_dwordx4 v[144:147], v54, s[36:39], 0 offen offset:0 sc1
    buffer_load_dwordx4 v[148:151], v54, s[36:39], 0 offen offset:64 sc1
    buffer_load_dwordx4 v[152:155], v54, s[36:39], 0 offen offset:128 sc1
    s_mov_b64 exec, -1
L_op_wait:
    s_cmp_lg_u32 s2, s2
    s_waitcnt vmcnt(0) lgkmcnt(8)
L_op_chk:
    v_mfma_f32_16x16x32_bf16 v[160:163], v[144:147], v[96:99], v[8:11]
    v_max3_u32 v44, v144, v145, v146
    v_max3_u32 v44, v44, v147, v148
    v_max3_u32 v44, v44, v149, v150
    v_mfma_f32_16x16x32_bf16 v[164:167], v[144:147], v[108:111], v[12:15]
    v_max3_u32 v44, v44, v151, v152
    v_max3_u32 v44, v44, v153, v154
    v_max_u32 v44, v44, v155
    v_mfma_f32_16x16x32_bf16 v[168:171], v[144:147], v[120:123], v[16:19]
    v_cmp_eq_u32 vcc, -1, v44
    s_cbranch_vccnz L_op_again
L_op_ok:
L_wo_body:
    v_mfma_f32_16x16x32_bf16 v[172:175], v[144:147], v[132:135], v[20:23]
    v_mfma_f32_16x16x32_bf16 v[160:163], v[148:151], v[100:103], v[160:163]
    v_mfma_f32_16x16x32_bf16 v[164:167], v[148:151], v[112:115], v[164:167]
    v_mfma_f32_16x16x32_bf16 v[168:171], v[148:151], v[124:127], v[168:171]
    v_mfma_f32_16x16x32_bf16 v[172:175], v[148:151], v[136:139], v[172:175]
    s_waitcnt lgkmcnt(0)
    v_mfma_f32_16x16x32_bf16 v[160:163], v[152:155], v[104:107], v[160:163]
    v_mfma_f32_16x16x32_bf16 v[168:171], v[152:155], v[128:131], v[168:171]
    v_mfma_f32_16x16x32_bf16 v[164:167], v[152:155], v[116:119], v[164:167]
    v_mfma_f32_16x16x32_bf16 v[172:175], v[152:155], v[140:143], v[172:175]
    s_nop 4
    v_pk_add_f32 v[160:161], v[160:161], v[162:163]
    v_add_f32 v44, v160, v161
    v_pk_add_f32 v[168:169], v[168:169], v[170:171]
    v_add_f32 v46, v168, v169
    v_pk_add_f32 v[164:165], v[164:165], v[166:167]
    v_add_f32 v45, v164, v165
    v_permlane32_swap_b32 v44, v46
    v_pk_add_f32 v[172:173], v[172:173], v[174:175]
    v_add_f32 v47, v172, v173
    v_add_f32 v44, v44, v46
    s_nop 0
    v_permlane32_swap_b32 v45, v47
    v_add_f32 v45, v45, v47
    s_nop 1
    v_permlane16_swap_b32 v44, v45
    v_add_f32 v44, v44, v45
    ds_write_b32 v55, v44 offset:51200
    s_waitcnt lgkmcnt(0)
    s_cbranch_scc1 L_wo_nb
    s_barrier
L_wo_nb:
    ds_read_b128 v[44:47], v61 offset:51200
    ds_read_b128 v[48:51], v61 offset:51216
    s_waitcnt lgkmcnt(1)
    v_pk_add_f32 v[44:45], v[44:45], v[46:47]
    s_waitcnt lgkmcnt(0)
    v_pk_add_f32 v[48:49], v[48:49], v[50:51]
    v_pk_add_f32 v[44:45], v[44:45], v[48:49]
    v_cvt_pk_bf16_f32 v44, v44, v45
    s_nop 1
    v_mov_b32_dpp v45, v44 quad_perm:[1,1,1,1] row_mask:0xf bank_mask:0xf
    v_mov_b32_dpp v46, v44 quad_perm:[2,2,2,2] row_mask:0xf bank_mask:0xf
    v_mov_b32_dpp v47, v44 quad_perm:[3,3,3,3] row_mask:0xf bank_mask:0xf
    s_cbranch_scc1 L_wo_end
    s_mov_b32 exec_lo, 0x11111111
    s_mov_b32 exec_hi, 0x11111111
    buffer_store_dwordx4 v[44:47], v57, s[36:39], 0 offen sc1
L_wo_end:
    s_cbranch_scc1 L_wo_ret
    s_cmp_lg_u32 s3, 0
    s_cbranch_scc1 L_done
    s_lshr_b32 s16, s6, 3
    s_and_b32 s17, s7, 3
    s_lshl2_add_u32 s16, s16, s17
    s_cmp_ge_u32 s16, 5
    s_cbranch_scc1 L_done
    s_mov_b64 exec, -1
    v_mov_b32 v7, 0
    ds_read_b32 v7, v7 offset:51012
    s_waitcnt lgkmcnt(0)
    v_readfirstlane_b32 s56, v7
    s_lshl_b32 s56, s56, 1
    s_xor_b32 s56, s56, s7
    s_and_b32 s56, s56, 4
    s_lshl_b32 s56, s56, 11
    s_lshl_b32 s18, s16, 8
    s_lshr_b32 s14, s56, 6
    s_add_u32 s18, s18, s14
    s_and_b32 s14, s6, 7
    s_lshl4_add_u32 s18, s14, s18
    v_and_b32 v48, 1, v0
    v_lshrrev_b32 v49, 4, v0
    v_lshl_add_u32 v49, v48, 2, v49
    v_lshl_add_u32 v62, v49, 1, s18
    buffer_load_ushort v57, v62, s[48:51], 0 offen
    v_bfe_u32 v49, v0, 1, 3
    v_lshrrev_b32 v50, 2, v49
    v_mul_u32_u24 v50, 16384, v50
    v_and_b32 v53, 3, v49
    v_mul_u32_u24 v53, 1280, v53
    v_add_u32 v53, v53, v50
    v_add_u32 v53, v53, v62
    s_and_b32 s18, s7, 3
    s_lshr_b32 s18, s18, 0
    s_lshl_b32 s18, s18, 16
    s_add_u32 s18, s18, s56
    s_add_u32 s18, s18, 32768
    s_add_u32 s19, s18, 32768
    buffer_load_ushort v50, v53, s[36:39], s18 offen sc1
    buffer_load_ushort v51, v53, s[36:39], s19 offen sc1
    v_lshrrev_b32 v49, 1, v0
    v_lshlrev_b32 v54, 7, v49
    v_lshl_add_u32 v54, v48, 4, v54
    s_lshl_b32 s16, s16, 16
    s_add_u32 s16, s16, s56
    s_and_b32 s14, s6, 4
    s_lshl_b32 s14, s14, 13
    s_add_u32 s16, s16, s14
    s_and_b32 s14, s6, 3
    s_lshl_b32 s14, s14, 5
    s_add_u32 s16, s16, s14
    s_add_u32 s16, s16, 294912
    s_add_u32 s17, s16, 4096
    s_add_u32 s14, s16, 16384
    s_cmp_eq_u32 s2, s2
    s_branch L_fin_body
L_fin_ret:
    s_mov_b64 exec, -1
    s_waitcnt vmcnt(0)
    s_branch L_h_chk
L_h_again:
    s_cmp_lg_u32 s15, 0
    s_cbranch_scc0 L_h_ok
    s_sub_u32 s15, s15, 1
    s_sleep 2
    s_mov_b64 exec, vcc
    buffer_load_ushort v50, v53, s[36:39], s18 offen sc1
    buffer_load_ushort v51, v53, s[36:39], s19 offen sc1
    s_mov_b64 exec, -1
    s_waitcnt vmcnt(0)
L_h_chk:
    v_max_u32 v44, v50, v51
    v_cmp_eq_u32 vcc, 0xffff, v44
    s_cbranch_vccnz L_h_again
L_h_ok:
    buffer_load_dwordx4 v[180:183], v54, s[36:39], s16 offen sc1
    buffer_load_dwordx4 v[184:187], v54, s[36:39], s17 offen sc1
    buffer_load_dwordx4 v[188:191], v54, s[36:39], s14 offen sc1
    v_lshlrev_b32 v50, 16, v50
    v_lshlrev_b32 v51, 16, v51
    v_lshlrev_b32 v57, 16, v57
    v_add_f32 v48, v50, v51
    s_nop 1
    v_add_f32_dpp v48, v48, v48 row_ror:8 row_mask:0xf bank_mask:0xf
    s_nop 1
    v_add_f32_dpp v48, v48, v48 row_ror:4 row_mask:0xf bank_mask:0xf
    s_nop 1
    v_add_f32_dpp v48, v48, v48 quad_perm:[2,3,0,1] row_mask:0xf bank_mask:0xf
    v_cvt_pk_bf16_f32 v56, 0, v48
    s_branch L_out_wait
.p2align 6
.fill 7, 4, 0xbf800000
L_out_again:
    s_cmp_lg_u32 s15, 0
    s_cbranch_scc0 L_out_ok
    s_sub_u32 s15, s15, 1
    s_mov_b64 exec, vcc
    buffer_load_dwordx4 v[180:183], v54, s[36:39], s16 offen sc1
    buffer_load_dwordx4 v[184:187], v54, s[36:39], s17 offen sc1
    buffer_load_dwordx4 v[188:191], v54, s[36:39], s14 offen sc1
    s_mov_b64 exec, -1
L_out_wait:
    s_cmp_lg_u32 s2, s2
    s_waitcnt vmcnt(0)
L_out_chk:
    v_max3_u32 v44, v180, v181, v182
    v_max3_u32 v44, v44, v183, v184
    v_max3_u32 v44, v44, v185, v186
    v_max3_u32 v44, v44, v187, v188
    v_max3_u32 v44, v44, v189, v190
    v_max_u32 v44, v44, v191
    v_cmp_eq_u32 vcc, -1, v44
    s_cbranch_vccnz L_out_again
L_out_ok:
L_fin_body:
    v_pk_add_f32 v[40:41], v[180:181], v[184:185]
    v_pk_add_f32 v[42:43], v[182:183], v[186:187]
    v_pk_add_f32 v[40:41], v[40:41], v[188:189]
    v_pk_add_f32 v[42:43], v[42:43], v[190:191]
    s_nop 1
    v_permlane32_swap_b32 v40, v42
    v_permlane32_swap_b32 v41, v43
    v_pk_add_f32 v[44:45], v[40:41], v[42:43]
    s_nop 1
    v_permlane16_swap_b32 v44, v45
    v_add_f32 v44, v44, v45
    s_nop 1
    v_add_f32_dpp v44, v44, v44 row_ror:8 row_mask:0xf bank_mask:0xf
    s_nop 1
    v_add_f32_dpp v44, v44, v44 row_ror:4 row_mask:0xf bank_mask:0xf
    s_nop 1
    v_add_f32_dpp v44, v44, v44 quad_perm:[2,3,0,1] row_mask:0xf bank_mask:0xf
    v_cvt_pk_bf16_f32 v44, 0, v44
    v_add_f32 v44, v44, v57
    v_cvt_pk_bf16_f32 v44, 0, v44
    v_add_f32 v44, v44, v56
    v_cvt_pk_bf16_f32 v44, v44, v44
    s_mov_b32 exec_lo, 0x30003
    s_mov_b32 exec_hi, 0x30003
    buffer_store_short v44, v62, s[52:55], 0 offen
    s_cbranch_scc1 L_fin_ret
    s_endpgm
L_ffn:
    s_cmp_eq_u32 s2, s2
    s_branch L_ff_body
L_ff_ret:
    v_and_b32 v4, 28, v53
L_s7f_rd:
    ds_read_b32 v5, v4 offset:50976
    s_waitcnt lgkmcnt(0)
    v_cmp_eq_u32 vcc, -1, v5
    s_cbranch_vccz L_s7f_ok
    s_cmp_eq_u32 s15, 0
    s_cbranch_scc1 L_s7f_ok
    s_sub_u32 s15, s15, 1
    s_sleep 2
    s_branch L_s7f_rd
L_s7f_ok:
    s_mov_b32 exec_hi, 0x0fffffff
    s_add_u32 m0, s19, 20480
    s_movk_i32 s11, 0
    buffer_load_dwordx4 v62, s[60:63], s11 offen nt lds
    s_add_u32 m0, s19, 21440
    s_movk_i32 s11, 3840
    buffer_load_dwordx4 v62, s[60:63], s11 offen nt lds
    s_add_u32 m0, s19, 22400
    s_movk_i32 s11, 7680
    buffer_load_dwordx4 v62, s[60:63], s11 offen nt lds
    s_add_u32 m0, s19, 23360
    s_movk_i32 s11, 11520
    buffer_load_dwordx4 v62, s[60:63], s11 offen nt lds
    s_add_u32 m0, s19, 24320
    s_movk_i32 s11, 15360
    buffer_load_dwordx4 v62, s[60:63], s11 offen nt lds
    s_mov_b64 exec, 0xfffff
    s_add_u32 m0, s19, 25280
    s_movk_i32 s11, 19200
    buffer_load_dwordx4 v62, s[60:63], s11 offen nt lds
    s_mov_b64 exec, -1
    v_mfma_f32_16x16x32_bf16 v[28:31], v[88:91], v[232:235], v[28:31]
    v_mfma_f32_16x16x32_bf16 v[32:35], v[88:91], v[236:239], v[32:35]
    v_mfma_f32_16x16x32_bf16 v[36:39], v[88:91], v[240:243], v[36:39]
    s_waitcnt vmcnt(11)
    v_mfma_f32_16x16x32_bf16 v[28:31], v[92:95], v[244:247], v[28:31]
    s_waitcnt vmcnt(10)
    v_mfma_f32_16x16x32_bf16 v[32:35], v[92:95], v[248:251], v[32:35]
    s_waitcnt vmcnt(9)
    v_mfma_f32_16x16x32_bf16 v[36:39], v[92:95], v[252:255], v[36:39]
    s_waitcnt vmcnt(8)
    v_mfma_f32_16x16x32_bf16 v[28:31], v[156:159], v[220:223], v[28:31]
    s_waitcnt vmcnt(7)
    v_mfma_f32_16x16x32_bf16 v[32:35], v[156:159], v[224:227], v[32:35]
    s_waitcnt vmcnt(6)
    v_mfma_f32_16x16x32_bf16 v[36:39], v[156:159], v[228:231], v[36:39]
    s_mov_b32 exec_lo, 0xff00ff
    s_mov_b32 exec_hi, 0xff00ff00
    s_nop 1
    ds_write_b128 v60, v[28:31] offset:0
    s_nop 0
    ds_write_b128 v60, v[32:35] offset:256
    s_nop 0
    ds_write_b128 v60, v[36:39] offset:512
    s_mov_b64 exec, -1
    s_waitcnt lgkmcnt(0)
    s_barrier
    ds_read_b32 v7, v17 offset:51012
    s_waitcnt lgkmcnt(0)
    v_readfirstlane_b32 s56, v7
    s_lshl_b32 s56, s56, 1
    s_xor_b32 s56, s56, s7
    s_and_b32 s56, s56, 4
    s_lshl_b32 s56, s56, 11
    s_barrier
    s_mul_i32 s64, s3, 245760
    s_add_u32 s64, s64, 147456
    s_add_u32 s65, s19, 1536
    s_mov_b32 m0, s65
    s_mov_b32 exec_lo, 0xffffffff
    s_mov_b32 exec_hi, 0xffffffff
    buffer_load_dwordx4 v59, s[44:47], s64 offen nt lds
    s_mov_b64 exec, -1
    s_add_u32 s65, s65, 1024
    s_add_u32 s64, s64, 98304
    s_add_u32 s64, s64, 147456
    s_add_u32 s65, s65, 1536
    s_mov_b32 m0, s65
    s_mov_b32 exec_lo, 0xffffffff
    s_mov_b32 exec_hi, 0xffffffff
    buffer_load_dwordx4 v59, s[44:47], s64 offen nt lds
    s_mov_b64 exec, -1
    s_add_u32 s65, s65, 1024
    s_add_u32 s64, s64, 98304
    s_waitcnt vmcnt(0)
    ds_read_b64_tr_b16 v[96:97], v40 offset:0
    ds_read_b64_tr_b16 v[98:99], v40 offset:128
    ds_read_b64_tr_b16 v[100:101], v40 offset:1024
    ds_read_b64_tr_b16 v[102:103], v40 offset:1152
    ds_read_b64_tr_b16 v[104:105], v40 offset:2048
    ds_read_b64_tr_b16 v[106:107], v40 offset:2176
    ds_read_b64_tr_b16 v[108:109], v40 offset:3072
    ds_read_b64_tr_b16 v[110:111], v40 offset:3200
    ds_read_b64_tr_b16 v[112:113], v40 offset:4096
    ds_read_b64_tr_b16 v[114:115], v40 offset:4224
    s_waitcnt lgkmcnt(0)
    s_add_u32 m0, s19, 0
    s_nop 0
    buffer_load_dwordx4 v8, s[36:39], s56 offen offset:0 sc1 lds
    s_add_u32 m0, s19, 960
    s_nop 0
    buffer_load_dwordx4 v8, s[36:39], s56 offen offset:64 sc1 lds
    s_add_u32 m0, s19, 1920
    s_nop 0
    buffer_load_dwordx4 v8, s[36:39], s56 offen offset:128 sc1 lds
    s_add_u32 m0, s19, 2880
    s_nop 0
    buffer_load_dwordx4 v8, s[36:39], s56 offen offset:192 sc1 lds
    s_add_u32 m0, s19, 3840
    s_nop 0
    buffer_load_dwordx4 v8, s[36:39], s56 offen offset:256 sc1 lds
    v_mfma_f32_16x16x32_bf16 v[20:23], v[136:139], v[96:99], 0
    v_mfma_f32_16x16x32_bf16 v[20:23], v[136:139], v[100:103], v[20:23]
    v_mfma_f32_16x16x32_bf16 v[20:23], v[136:139], v[104:107], v[20:23]
    v_mfma_f32_16x16x32_bf16 v[20:23], v[136:139], v[108:111], v[20:23]
    v_mfma_f32_16x16x32_bf16 v[20:23], v[136:139], v[112:115], v[20:23]
    s_mov_b64 exec, 0xffff
    s_nop 6
    ds_write_b32 v55, v20 offset:52224
    s_mov_b64 exec, -1
    s_waitcnt vmcnt(5)
    ds_read_b64_tr_b16 v[116:117], v41 offset:20480
    ds_read_b64_tr_b16 v[118:119], v41 offset:21760
    ds_read_b64_tr_b16 v[120:121], v41 offset:20488
    ds_read_b64_tr_b16 v[122:123], v41 offset:21768
    ds_read_b64_tr_b16 v[124:125], v41 offset:20496
    ds_read_b64_tr_b16 v[126:127], v41 offset:21776
    ds_read_b64_tr_b16 v[128:129], v41 offset:20504
    ds_read_b64_tr_b16 v[130:131], v41 offset:21784
    ds_read_b64_tr_b16 v[132:133], v41 offset:20512
    ds_read_b64_tr_b16 v[134:135], v41 offset:21792
    s_branch L_yp_land
L_yp_bulk:
    s_add_u32 m0, s19, 0
    s_nop 0
    buffer_load_dwordx4 v8, s[36:39], s56 offen offset:0 sc1 lds
    s_add_u32 m0, s19, 960
    s_nop 0
    buffer_load_dwordx4 v8, s[36:39], s56 offen offset:64 sc1 lds
    s_add_u32 m0, s19, 1920
    s_nop 0
    buffer_load_dwordx4 v8, s[36:39], s56 offen offset:128 sc1 lds
    s_add_u32 m0, s19, 2880
    s_nop 0
    buffer_load_dwordx4 v8, s[36:39], s56 offen offset:192 sc1 lds
    s_add_u32 m0, s19, 3840
    s_nop 0
    buffer_load_dwordx4 v8, s[36:39], s56 offen offset:256 sc1 lds
L_yp_land:
    s_waitcnt vmcnt(0)
    ds_read_b128 v[160:163], v9 offset:0
    ds_read_b128 v[164:167], v9 offset:1024
    ds_read_b128 v[168:171], v9 offset:2048
    ds_read_b128 v[172:175], v9 offset:3072
    ds_read_b128 v[176:179], v9 offset:4096
    s_branch L_yp_wait
.p2align 6
.fill 4, 4, 0xbf800000
L_yp_again:
    s_cmp_lg_u32 s15, 0
    s_cbranch_scc0 L_yp_ok
    s_sub_u32 s15, s15, 1
    s_bcnt1_i32_b64 s11, vcc
    s_cmp_gt_u32 s11, 16
    s_cbranch_scc1 L_yp_bulk
    s_mov_b64 exec, vcc
    buffer_load_dwordx4 v[160:163], v54, s[36:39], s56 offen offset:0 sc1
    buffer_load_dwordx4 v[164:167], v54, s[36:39], s56 offen offset:64 sc1
    buffer_load_dwordx4 v[168:171], v54, s[36:39], s56 offen offset:128 sc1
    buffer_load_dwordx4 v[172:175], v54, s[36:39], s56 offen offset:192 sc1
    buffer_load_dwordx4 v[176:179], v54, s[36:39], s56 offen offset:256 sc1
    s_mov_b64 exec, -1
L_yp_wait:
    s_cmp_lg_u32 s2, s2
    s_waitcnt vmcnt(0) lgkmcnt(0)
L_yp_chk:
    v_mfma_f32_16x16x32_bf16 v[184:187], v[160:163], v[160:163], 0
    v_max3_u32 v44, v160, v161, v162
    v_max3_u32 v44, v44, v163, v164
    v_max3_u32 v44, v44, v165, v166
    v_mfma_f32_16x16x32_bf16 v[184:187], v[164:167], v[164:167], v[184:187]
    v_max3_u32 v44, v44, v167, v168
    v_max3_u32 v44, v44, v169, v170
    v_max3_u32 v44, v44, v171, v172
    v_mfma_f32_16x16x32_bf16 v[184:187], v[168:171], v[168:171], v[184:187]
    v_max3_u32 v44, v44, v173, v174
    v_max3_u32 v44, v44, v175, v176
    v_max3_u32 v44, v44, v177, v178
    v_mfma_f32_16x16x32_bf16 v[184:187], v[172:175], v[172:175], v[184:187]
    v_max_u32 v44, v44, v179
    v_cmp_eq_u32 vcc, -1, v44
    s_cbranch_vccnz L_yp_again
L_yp_ok:
L_ff_body:
    v_mfma_f32_16x16x32_bf16 v[184:187], v[176:179], v[176:179], v[184:187]
    v_mfma_f32_16x16x32_bf16 v[188:191], v[160:163], v[136:139], 0
    v_mfma_f32_16x16x32_bf16 v[188:191], v[164:167], v[136:139], v[188:191]
    v_mfma_f32_16x16x32_bf16 v[188:191], v[168:171], v[136:139], v[188:191]
    v_mfma_f32_16x16x32_bf16 v[188:191], v[172:175], v[136:139], v[188:191]
    v_mfma_f32_16x16x32_bf16 v[188:191], v[176:179], v[136:139], v[188:191]
    v_mfma_f32_16x16x32_bf16 v[180:183], v[160:163], v[96:99], 0
    s_nop 1
    v_pk_add_f32 v[184:185], v[184:185], v[186:187]
    v_add_f32 v45, v184, v185
    v_mfma_f32_16x16x32_bf16 v[180:183], v[164:167], v[100:103], v[180:183]
    s_nop 0
    v_add_f32_dpp v45, v45, v45 row_ror:8 row_mask:0xf bank_mask:0xf
    v_mfma_f32_16x16x32_bf16 v[180:183], v[168:171], v[104:107], v[180:183]
    v_pk_add_f32 v[188:189], v[188:189], v[190:191]
    v_add_f32_dpp v45, v45, v45 row_ror:4 row_mask:0xf bank_mask:0xf
    v_mfma_f32_16x16x32_bf16 v[180:183], v[172:175], v[108:111], v[180:183]
    v_add_f32 v46, v188, v189
    v_add_f32_dpp v45, v45, v45 quad_perm:[2,3,0,1] row_mask:0xf bank_mask:0xf
    v_mfma_f32_16x16x32_bf16 v[180:183], v[176:179], v[112:115], v[180:183]
    s_nop 0
    v_add_f32_dpp v45, v45, v45 quad_perm:[1,0,3,2] row_mask:0xf bank_mask:0xf
    v_cndmask_b32 v45, v45, v46, s[8:9]
    v_mul_f32 v45, s66, v45
    s_nop 3
    v_pk_add_f32 v[180:181], v[180:181], v[182:183]
    v_add_f32 v44, v180, v181
    s_nop 1
    v_permlane32_swap_b32 v44, v45
    v_add_f32 v46, v44, v45
    v_add_f32 v44, v44, v45
    s_nop 1
    v_permlane16_swap_b32 v44, v46
    v_add_f32 v44, v44, v46
    ds_write_b32 v55, v44 offset:51200
    s_waitcnt lgkmcnt(0)
    s_cbranch_scc1 L_ff_nb
    s_barrier
L_ff_nb:
    ds_read_b128 v[48:51], v17 offset:51456
    ds_read_b128 v[24:27], v17 offset:51472
    ds_read_b128 v[44:47], v61 offset:51200
    ds_read_b128 v[20:23], v61 offset:52224
    s_waitcnt lgkmcnt(2)
    v_pk_add_f32 v[48:49], v[48:49], v[50:51]
    v_pk_add_f32 v[24:25], v[24:25], v[26:27]
    v_pk_add_f32 v[48:49], v[48:49], v[24:25]
    v_fma_f32 v49, -v48, v48, v49
    v_cvt_pk_bf16_f32 v49, 0, abs(v49)
    v_add_f32 v49, 0x37280000, v49
    v_cvt_pk_bf16_f32 v49, 0, v49
    v_sqrt_f32 v49, v49
    s_waitcnt lgkmcnt(0)
    v_cvt_pk_bf16_f32 v48, 0, v48
    v_pk_add_f32 v[44:45], v[44:45], v[46:47]
    v_cvt_pk_bf16_f32 v49, 0, v49
    v_rcp_f32 v51, v49
    v_pk_add_f32 v[20:21], v[20:21], v[22:23]
    v_pk_fma_f32 v[44:45], v[20:21], v[48:49], v[44:45] op_sel_hi:[1,0,1] neg_lo:[1,0,0] neg_hi:[1,0,0]
    v_add_f32 v44, v44, v45
    v_mul_f32 v44, v44, v51
    v_cvt_pk_bf16_f32 v44, 0, v44
    v_add_f32 v44, v44, v56
    v_cvt_pk_bf16_f32 v44, 0, v44
    v_max_f32 v44, 0, v44
    v_mul_f32 v44, v44, v44
    s_nop 1
    v_mov_b32_dpp v45, v44 quad_perm:[1,1,3,3] row_mask:0xf bank_mask:0xf
    v_cvt_pk_bf16_f32 v44, v44, v45
    v_and_b32 v200, v44, v140
    s_nop 0
    v_and_b32_dpp v201, v44, v140 row_shl:2 row_mask:0xf bank_mask:0xf bound_ctrl:0
    v_and_b32_dpp v202, v44, v140 row_shl:4 row_mask:0xf bank_mask:0xf bound_ctrl:0
    v_and_b32_dpp v203, v44, v140 row_shl:6 row_mask:0xf bank_mask:0xf bound_ctrl:0
    v_and_b32_dpp v204, v44, v141 row_shr:1 row_mask:0xf bank_mask:0xf bound_ctrl:0
    v_and_b32_dpp v205, v44, v141 row_shl:1 row_mask:0xf bank_mask:0xf bound_ctrl:0
    v_and_b32_dpp v206, v44, v141 row_shl:3 row_mask:0xf bank_mask:0xf bound_ctrl:0
    v_and_b32_dpp v207, v44, v141 row_shl:5 row_mask:0xf bank_mask:0xf bound_ctrl:0
    v_mfma_f32_16x16x32_bf16 v[192:195], v[116:119], v[200:203], 0
    v_and_b32_dpp v208, v44, v142 row_shr:2 row_mask:0xf bank_mask:0xf bound_ctrl:0
    v_and_b32 v209, v44, v142
    v_and_b32_dpp v210, v44, v142 row_shl:2 row_mask:0xf bank_mask:0xf bound_ctrl:0
    v_and_b32_dpp v211, v44, v142 row_shl:4 row_mask:0xf bank_mask:0xf bound_ctrl:0
    v_mfma_f32_16x16x32_bf16 v[192:195], v[120:123], v[204:207], v[192:195]
    v_and_b32_dpp v212, v44, v143 row_shr:3 row_mask:0xf bank_mask:0xf bound_ctrl:0
    v_and_b32_dpp v213, v44, v143 row_shr:1 row_mask:0xf bank_mask:0xf bound_ctrl:0
    v_and_b32_dpp v214, v44, v143 row_shl:1 row_mask:0xf bank_mask:0xf bound_ctrl:0
    v_and_b32_dpp v215, v44, v143 row_shl:3 row_mask:0xf bank_mask:0xf bound_ctrl:0
    v_mfma_f32_16x16x32_bf16 v[192:195], v[124:127], v[208:211], v[192:195]
    v_and_b32_dpp v216, v44, v144 row_shr:4 row_mask:0xf bank_mask:0xf bound_ctrl:0
    v_and_b32_dpp v217, v44, v144 row_shr:2 row_mask:0xf bank_mask:0xf bound_ctrl:0
    v_and_b32 v218, v44, v144
    v_and_b32_dpp v219, v44, v144 row_shl:2 row_mask:0xf bank_mask:0xf bound_ctrl:0
    v_mfma_f32_16x16x32_bf16 v[192:195], v[128:131], v[212:215], v[192:195]
    s_nop 0
    v_mfma_f32_16x16x32_bf16 v[192:195], v[132:135], v[216:219], v[192:195]
    s_cbranch_scc1 L_ff_end
    s_mov_b32 exec_lo, 0x1f1f1f1f
    s_mov_b32 exec_hi, 0x1f1f1f1f
    s_nop 4
    buffer_store_dwordx4 v[192:195], v19, s[36:39], 0 offen sc1
L_ff_end:
    s_cbranch_scc1 L_ff_ret
    s_endpgm
L_exit:
    s_endpgm
.section .rodata,"a"
.p2align 6
.amdhsa_kernel sequential_preLN__sliding_block_cached__dense_activation_squared_relu__decode_kernel
  .amdhsa_next_free_vgpr 256
  .amdhsa_next_free_sgpr 102
  .amdhsa_accum_offset 256
  .amdhsa_group_segment_fixed_size 0
  .amdhsa_kernarg_size 104
  .amdhsa_user_sgpr_count 2
  .amdhsa_user_sgpr_kernarg_segment_ptr 1
  .amdhsa_system_sgpr_workgroup_id_x 1
  .amdhsa_float_denorm_mode_32 3
.end_amdhsa_kernel
```
